```python
import torch

def _softmax(x, axis=-1):
    return torch.softmax(x, dim=axis)

def _gelu(x):
    return torch.nn.functional.gelu(x, approximate='tanh')

def _silu(x):
    return torch.nn.functional.silu(x)

def _sigmoid(x):
    return torch.sigmoid(x)

def _layernorm(x, axis=-1, eps=1e-05):
    m = x.mean(dim=axis, keepdim=True)
    v = x.var(dim=axis, keepdim=True, unbiased=False)
    return (x - m) / torch.sqrt(v + eps)

def _scatter_add(tgt, idx, src, axis=0):
    return tgt.clone().index_add_(axis, idx, src)

def _segment_sum(src, seg, n):
    out = torch.zeros((n,) + src.shape[1:], dtype=src.dtype)
    return out.index_add_(0, seg, src)

def _pad(x, pw):
    flat = tuple((v for pair in reversed(pw) for v in pair))
    return torch.nn.functional.pad(x, flat)
kernel_name = 'adaLN_cond__sliding_block_cached__swiglu_ffn__decode'

def setup_inputs():

    _w = lambda a: (lambda t: t.to(torch.bfloat16) if t.is_floating_point() else t)(torch.as_tensor(a))

    def _A_setup():
        B, Sq, D = (1, 1, 512)
        Hq, Hkv, Sk, Dh = (32, 8, 65536, 128)
        assert Hq % Hkv == 0, (Hq, Hkv)
        return {'x': _w((lambda *s: torch.randn(*s, dtype=torch.bfloat16) * 0.05)(B, Sq, D)), 'k_cache': _w((lambda *s: torch.randn(*s, dtype=torch.bfloat16) * 3.2)(B, Hkv, Sk, Dh)), 'v_cache': _w((lambda *s: torch.randn(*s, dtype=torch.bfloat16) * 0.4)(B, Hkv, Sk, Dh)), 'wq': _w((lambda *s: torch.randn(*s, dtype=torch.bfloat16) * 3.2)(D, Hq * Dh) * D ** (-0.5)), 'wo': _w((lambda *s: torch.randn(*s, dtype=torch.bfloat16) * 0.4)(Hq * Dh, D) * (Hq * Dh) ** (-0.5))}
    _A_in = _A_setup()

    def _B_setup():
        B, S, D, F = (1, 1, 512, 1792)
        return {'x': _w((lambda *s: torch.randn(*s, dtype=torch.bfloat16) * 0.05)(B, S, D)), 'w_gate': _w((lambda *s: torch.randn(*s, dtype=torch.bfloat16) * 0.05)(D, F)), 'w_up': _w((lambda *s: torch.randn(*s, dtype=torch.bfloat16) * 0.05)(D, F)), 'w_down': _w((lambda *s: torch.randn(*s, dtype=torch.bfloat16) * 0.05)(F, D))}
    _B_in = _B_setup()
    return {'A_x': _A_in['x'], 'A_k_cache': _A_in['k_cache'], 'A_v_cache': _A_in['v_cache'], 'A_wq': _A_in['wq'], 'A_wo': _A_in['wo'], 'B_x': _B_in['x'], 'B_w_gate': _B_in['w_gate'], 'B_w_up': _B_in['w_up'], 'B_w_down': _B_in['w_down'], 'c': _w((lambda *s: torch.randn(*s, dtype=torch.bfloat16) * 0.1)(1, 512) * 8.0), 'w_mod': _w((lambda *s: torch.randn(*s, dtype=torch.bfloat16) * 0.1)(512, 6 * 512) * 512 ** (-0.5) * 8.0)}

def reference(A_x, A_k_cache, A_v_cache, A_wq, A_wo, B_x, B_w_gate, B_w_up, B_w_down, c, w_mod):

    def _A_ref(x, k_cache, v_cache, wq, wo):
        B, Sq, D = x.shape
        Hq, Dh = (32, 128)
        Hkv, Sk = (k_cache.shape[1], k_cache.shape[2])
        W = min(4096, max(256, Sk // 4))
        rep = Hq // Hkv
        q = (lambda x, *d: x.permute(*d))((x @ wq).reshape(B, Sq, Hq, Dh), 0, 2, 1, 3)
        k = (lambda x, n, axis: torch.repeat_interleave(x, n, dim=axis))(k_cache[:, :, Sk - W:, :], rep, axis=1)
        v = (lambda x, n, axis: torch.repeat_interleave(x, n, dim=axis))(v_cache[:, :, Sk - W:, :], rep, axis=1)
        scores = torch.einsum('bhqd,bhkd->bhqk', q, k) * Dh ** (-0.5)
        p = _softmax(scores, axis=-1)
        o = torch.einsum('bhqk,bhkd->bhqd', p, v)
        return (lambda x, *d: x.permute(*d))(o, 0, 2, 1, 3).reshape(B, Sq, Hq * Dh) @ wo

    def _B_ref(x, w_gate, w_up, w_down):
        g = _silu(x @ w_gate)
        u = x @ w_up
        return g * u @ w_down
    x = A_x
    mod = (_silu(c) @ w_mod).reshape(c.shape[0], 6, 1, -1)
    sa, ca, ga, sb, cb, gb = (mod[:, 0].clone(), mod[:, 1].clone(), mod[:, 2].clone(), mod[:, 3].clone(), mod[:, 4].clone(), mod[:, 5].clone())
    h = _layernorm(x, axis=-1) * (1 + ca) + sa
    x = x + ga * _A_ref(h, A_k_cache, A_v_cache, A_wq, A_wo)
    h = _layernorm(x, axis=-1) * (1 + cb) + sb
    x = x + gb * _B_ref(h, B_w_gate, B_w_up, B_w_down)
    return x
```

```asm
; @launch grid=(256,1,1) block=(512,1,1) lds=18432
.amdgcn_target "amdgcn-amd-amdhsa--gfx950"
.text
.globl adaLN_cond__sliding_block_cached__swiglu_ffn__decode_kernel
.p2align 12
.fill 832, 4, 0xbf810000
.p2align 8
.type adaLN_cond__sliding_block_cached__swiglu_ffn__decode_kernel,@function
adaLN_cond__sliding_block_cached__swiglu_ffn__decode_kernel:
    s_load_dwordx16 s[4:19], s[0:1], 0
    s_load_dwordx8 s[20:27], s[0:1], 64
    s_load_dwordx4 s[28:31], s[0:1], 96
    v_readfirstlane_b32 s3, v0
    s_and_b32 s33, s2, 7
    s_lshr_b32 s34, s2, 3
    v_and_b32 v1, 63, v0
    s_lshr_b32 s3, s3, 6
    s_lshr_b32 s42, s2, 5
    s_or_b32 s42, s42, s3
    s_cmp_ge_u32 s42, 4
    s_cbranch_scc1 Ldisp
    s_getreg_b32 s38, hwreg(HW_REG_XCC_ID, 0, 4)
    v_lshrrev_b32 v4, 3, v0
    v_bfe_u32 v5, v0, 0, 1
    v_lshl_add_u32 v4, s34, 5, v4
    s_lshl_b32 s42, s33, 1
    v_lshrrev_b32 v7, 1, v1
    v_lshl_add_u32 v7, s34, 5, v7
    v_mad_u32_u24 v5, v7, 48, v5
    v_add_lshl_u32 v5, v5, s42, 7
    s_lshl4_add_u32 s43, s42, s34
    s_bitset1_b32 s38, 7
    v_mov_b32 v126, s43
    v_mov_b32 v127, s38
    v_and_b32 v6, 7, v0
    v_lshl_add_u32 v6, v4, 6, v6
    s_lshl_b32 s42, s33, 3
    v_add_lshl_u32 v6, v6, s42, 7
    s_cmp_lg_u32 s3, 0
    s_cbranch_scc1 LA0
    s_mov_b64 exec, 1
    s_waitcnt lgkmcnt(0)
    global_store_byte v126, v127, s[28:29]
    s_mov_b64 exec, -1
    global_load_dword v80, v5, s[24:25]
LA0:
    s_waitcnt lgkmcnt(0)
    global_load_dword v81, v6, s[10:11]
LA:
    s_lshl_b32 s42, s33, 12
    s_add_u32 s42, s42, s34
    s_lshl2_add_u32 s42, s42, s3
    s_and_b32 s43, s3, 4
    s_mulk_i32 s43, 127
    s_add_u32 s42, s42, s43
    s_addk_i32 s42, 15360
    s_lshl_b32 s42, s42, 10
    v_lshl_add_u32 v2, v1, 4, s42
    v_and_b32 v5, 12, v0
    v_and_b32 v6, 48, v0
    v_mad_u32_u24 v3, v5, 48, v2
    v_mad_i32_i24 v3, v6, -12, v3
    s_load_dword s32, s[30:31], 0
    global_load_dwordx4 v[8:11], v3, s[6:7] nt
    v_add_u32 v3, 0x10000, v3
    global_load_dwordx4 v[12:15], v3, s[6:7] nt
    v_add_u32 v3, 0x10000, v3
    global_load_dwordx4 v[16:19], v3, s[6:7] nt
    v_add_u32 v3, 0x10000, v3
    global_load_dwordx4 v[20:23], v3, s[6:7] nt
    v_add_u32 v3, 0x10000, v3
    global_load_dwordx4 v[24:27], v3, s[6:7] nt
    v_add_u32 v3, 0x10000, v3
    global_load_dwordx4 v[28:31], v3, s[6:7] nt
    v_add_u32 v3, 0x10000, v3
    global_load_dwordx4 v[32:35], v3, s[6:7] nt
    v_add_u32 v3, 0x10000, v3
    global_load_dwordx4 v[36:39], v3, s[6:7] nt
    s_branch LA2
Ldisp:
    s_cmpk_ge_u32 s2, 256
    s_cbranch_scc1 Lexit0
    s_cmp_lt_u32 s3, 4
    s_cbranch_scc0 LH
    s_cmp_ge_u32 s34, 24
    s_cbranch_scc1 LM
    s_branch LQ
LH:
    s_cmp_lg_u32 s3, 7
    s_cbranch_scc1 Lh1
    s_cmp_lt_u32 s34, 16
    s_cbranch_scc1 Lh1
    s_getreg_b32 s38, hwreg(HW_REG_XCC_ID, 0, 4)
    s_or_b32 s38, s38, 0x80
    s_mul_i32 s38, s38, 0x01010101
    s_lshl_b32 s42, s33, 5
    s_add_u32 s42, s42, s34
    v_mov_b32 v126, s42
    v_mov_b32 v127, s38
    s_mov_b64 exec, 1
    s_waitcnt lgkmcnt(0)
    global_store_byte v126, v127, s[28:29]
    global_load_ubyte v127, v126, s[28:29] sc1
    s_cmp_ge_u32 s34, 24
    s_cbranch_scc1 Lh1
    s_mov_b64 exec, 0x1ffff
    s_mul_i32 s42, s34, 1024
    s_mul_i32 s43, s33, 8448
    s_add_u32 s43, s43, 933888
    s_add_u32 s43, s43, s42
    s_mul_i32 s42, s34, 1152
    s_mul_i32 s44, s33, 9344
    s_add_u32 s44, s44, 848896
    s_add_u32 s44, s44, s42
    v_mov_b32 v2, s43
    v_mov_b32 v3, s44
    v_cmp_lt_u32 vcc, 7, v1
    s_nop 1
    v_cndmask_b32 v2, v2, v3, vcc
    v_lshl_add_u32 v2, v1, 7, v2
    global_load_dword v3, v2, s[30:31] sc1
Lh1:
    s_mov_b64 exec, 0
    s_cmp_ge_u32 s34, 24
    s_cbranch_scc0 Lhq2
    s_cmp_eq_u32 s3, 4
    s_cbranch_scc1 LFH
    s_cmp_eq_u32 s3, 5
    s_cbranch_scc1 PM3
    s_cmp_eq_u32 s3, 6
    s_cbranch_scc1 PM2
    s_branch PM1
Lhq2:
    s_cmp_ge_u32 s34, 16
    s_cbranch_scc0 Lhm3
    s_cmp_eq_u32 s3, 4
    s_cbranch_scc1 PQ5
    s_cmp_eq_u32 s3, 5
    s_cbranch_scc1 PQ4
    s_cmp_eq_u32 s3, 6
    s_cbranch_scc1 PQ2
    s_branch PQ3
Lhm3:
    s_cmp_eq_u32 s3, 4
    s_cbranch_scc1 PA3
    s_cmp_eq_u32 s3, 5
    s_cbranch_scc1 PA2
    s_cmp_eq_u32 s3, 6
    s_cbranch_scc1 PA6
    s_branch PA1
LAres:
    s_mov_b64 exec, -1
    s_getreg_b32 s38, hwreg(HW_REG_XCC_ID, 0, 4)
    s_or_b32 s38, s38, 0x80
    s_mul_i32 s38, s38, 0x01010101
    v_mov_b32 v126, 0
    v_mov_b32 v127, 0
    s_waitcnt lgkmcnt(0)
    s_branch LA
LA2:
    s_mov_b32 s35, 0x100000
    s_mov_b32 s36, 0x05040100
    s_mov_b32 s37, 0x07060302
    v_mov_b32 v108, 0
    v_mov_b32 v109, 0
    v_mov_b32 v110, 0
    v_mov_b32 v111, 0
    v_mov_b32 v112, 0
    v_mov_b32 v113, 0
    v_mov_b32 v114, 0
    v_mov_b32 v115, 0
    v_mov_b32 v116, 0
    v_mov_b32 v117, 0
    v_mov_b32 v118, 0
    v_mov_b32 v119, 0
    v_mov_b32 v120, 0
    v_mov_b32 v121, 0
    v_mov_b32 v122, 0
    v_mov_b32 v123, 0
    v_lshlrev_b32 v124, 4, v1
    v_and_b32 v125, 3, v1
    v_lshlrev_b32 v125, 2, v125
    v_mov_b32 v3, 0
    v_mov_b32 v4, 0xff800000
    ds_write2_b32 v125, v4, v3 offset0:4 offset1:8
    s_mov_b64 s[0:1], s[12:13]
    s_mov_b64 s[100:101], s[8:9]
    s_mov_b64 s[40:41], s[20:21]
    s_waitcnt lgkmcnt(0)
    s_barrier
    s_mul_i32 s32, s32, 0x9e3779b1
    s_add_u32 s32, s32, 0x7f4a7c15
    s_cmp_lt_u32 s3, 4
    s_cbranch_scc1 Lxo9
    s_lshl_b32 s42, s33, 5
    s_load_dwordx8 s[4:11], s[28:29], s42
    s_mov_b32 s39, s38
Lxo9:
    global_load_dwordx4 v[40:43], v2, s[100:101] nt
    v_add_u32 v2, 0x10000, v2
    global_load_dwordx4 v[44:47], v2, s[100:101] nt
    v_add_u32 v2, 0x10000, v2
    s_cmp_ge_u32 s3, 4
    s_cbranch_scc1 Ly4
    s_mov_b32 s45, s3
    global_load_dwordx4 v[48:51], v2, s[100:101] nt
    v_add_u32 v2, 0x10000, v2
    global_load_dwordx4 v[52:55], v2, s[100:101] nt
    v_add_u32 v2, 0x10000, v2
    global_load_dwordx4 v[56:59], v2, s[100:101] nt
    v_add_u32 v2, 0x10000, v2
    global_load_dwordx4 v[60:63], v2, s[100:101] nt
    v_add_u32 v2, 0x10000, v2
    global_load_dwordx4 v[64:67], v2, s[100:101] nt
    v_add_u32 v2, 0x10000, v2
    global_load_dwordx4 v[68:71], v2, s[100:101] nt
    s_mul_i32 s43, s33, 9344
    s_add_u32 s43, s43, 869376
    s_lshl_b32 s42, s45, 8
    s_lshl3_add_u32 s44, s42, s43
    s_add_u32 s42, s42, s43
    s_add_u32 s43, s44, 1984
    s_add_u32 s28, s30, s42
    s_addc_u32 s29, s31, 0
    v_lshl_add_u32 v7, v1, 2, s45
    v_lshlrev_b32 v7, 4, v7
    s_mov_b64 exec, 1
Lretry7:
    s_cmp_lt_u32 s44, s43
    s_cbranch_scc0 Lfglc
    s_load_dwordx2 s[12:13], s[30:31], s44
    s_add_u32 s44, s44, 64
Lfl8:
    s_waitcnt lgkmcnt(0)
    s_cmp_lg_u32 s12, s32
    s_cbranch_scc1 Lretry7
    s_cmp_lg_u32 s13, s32
    s_cbranch_scc1 Lretry7
    s_load_dwordx16 s[44:59], s[28:29], -1024
    s_load_dwordx16 s[80:95], s[28:29], -960
    s_load_dwordx16 s[12:27], s[28:29], -896
    s_load_dwordx4 s[60:63], s[28:29], -832
    s_load_dwordx4 s[96:99], s[28:29], -816
    s_load_dwordx8 s[4:11], s[28:29], -800
    s_waitcnt lgkmcnt(0)
    v_mov_b64 v[72:73], s[44:45]
    v_mov_b64 v[74:75], s[46:47]
    s_lshl_b32 exec_lo, exec_lo, 1
    v_mov_b64 v[72:73], s[48:49]
    v_mov_b64 v[74:75], s[50:51]
    s_lshl_b32 exec_lo, exec_lo, 1
    v_mov_b64 v[72:73], s[52:53]
    v_mov_b64 v[74:75], s[54:55]
    s_lshl_b32 exec_lo, exec_lo, 1
    v_mov_b64 v[72:73], s[56:57]
    v_mov_b64 v[74:75], s[58:59]
    s_lshl_b32 exec_lo, exec_lo, 1
    v_mov_b64 v[72:73], s[80:81]
    v_mov_b64 v[74:75], s[82:83]
    s_lshl_b32 exec_lo, exec_lo, 1
    v_mov_b64 v[72:73], s[84:85]
    v_mov_b64 v[74:75], s[86:87]
    s_lshl_b32 exec_lo, exec_lo, 1
    v_mov_b64 v[72:73], s[88:89]
    v_mov_b64 v[74:75], s[90:91]
    s_lshl_b32 exec_lo, exec_lo, 1
    v_mov_b64 v[72:73], s[92:93]
    v_mov_b64 v[74:75], s[94:95]
    s_lshl_b32 exec_lo, exec_lo, 1
    v_mov_b64 v[72:73], s[12:13]
    v_mov_b64 v[74:75], s[14:15]
    s_lshl_b32 exec_lo, exec_lo, 1
    v_mov_b64 v[72:73], s[16:17]
    v_mov_b64 v[74:75], s[18:19]
    s_lshl_b32 exec_lo, exec_lo, 1
    v_mov_b64 v[72:73], s[20:21]
    v_mov_b64 v[74:75], s[22:23]
    s_lshl_b32 exec_lo, exec_lo, 1
    v_mov_b64 v[72:73], s[24:25]
    v_mov_b64 v[74:75], s[26:27]
    s_lshl_b32 exec_lo, exec_lo, 1
    v_mov_b64 v[72:73], s[60:61]
    v_mov_b64 v[74:75], s[62:63]
    s_lshl_b32 exec_lo, exec_lo, 1
    v_mov_b64 v[72:73], s[96:97]
    v_mov_b64 v[74:75], s[98:99]
    s_lshl_b32 exec_lo, exec_lo, 1
    v_mov_b64 v[72:73], s[4:5]
    v_mov_b64 v[74:75], s[6:7]
    s_lshl_b32 exec_lo, exec_lo, 1
    v_mov_b64 v[72:73], s[8:9]
    v_mov_b64 v[74:75], s[10:11]
    s_mov_b32 exec_lo, 0xffff
    ds_write_b128 v7, v[72:75] offset:64
    s_mov_b64 exec, -1
    s_branch Lsp5
PA1:
    s_branch LAres
Lfglc:
    s_sub_u32 s35, s35, 1
    s_cbranch_scc1 Lexit
    s_load_dwordx2 s[12:13], s[30:31], s44 glc
    s_branch Lfl8
Ly4:
    s_setprio 1
    s_waitcnt vmcnt(2)
Lsp5:
    s_waitcnt lgkmcnt(0)
    s_barrier
    ds_read_b128 v[104:107], v124 offset:64
    s_mov_b32 s46, 0x000f000f
    s_mov_b32 s47, 0x000f000f
    s_waitcnt vmcnt(8) lgkmcnt(0)
    v_mfma_f32_16x16x32_bf16 v[4:7], v[8:11], v[104:107], 0
    v_mfma_f32_16x16x32_bf16 v[8:11], v[12:15], v[104:107], 0
    v_mfma_f32_16x16x32_bf16 v[12:15], v[16:19], v[104:107], 0
    v_mfma_f32_16x16x32_bf16 v[16:19], v[20:23], v[104:107], 0
    v_mfma_f32_16x16x32_bf16 v[20:23], v[24:27], v[104:107], 0
    v_mfma_f32_16x16x32_bf16 v[24:27], v[28:31], v[104:107], 0
    v_mfma_f32_16x16x32_bf16 v[28:31], v[32:35], v[104:107], 0
    v_mfma_f32_16x16x32_bf16 v[32:35], v[36:39], v[104:107], 0
    s_nop 0
    v_add_f32_dpp v36, v5, v4 row_ror:12 row_mask:0xf bank_mask:0x1
    v_add_f32_dpp v37, v9, v8 row_ror:12 row_mask:0xf bank_mask:0x1
    v_add_f32_dpp v38, v14, v13 row_ror:12 row_mask:0xf bank_mask:0x2
    v_add_f32_dpp v39, v18, v17 row_ror:12 row_mask:0xf bank_mask:0x2
    v_add_f32_dpp v36, v6, v36 row_ror:8 row_mask:0xf bank_mask:0x1
    v_add_f32_dpp v37, v10, v37 row_ror:8 row_mask:0xf bank_mask:0x1
    v_add_f32_dpp v38, v15, v38 row_ror:8 row_mask:0xf bank_mask:0x2
    v_add_f32_dpp v39, v19, v39 row_ror:8 row_mask:0xf bank_mask:0x2
    v_add_f32_dpp v36, v7, v36 row_ror:4 row_mask:0xf bank_mask:0x1
    v_add_f32_dpp v37, v11, v37 row_ror:4 row_mask:0xf bank_mask:0x1
    v_add_f32_dpp v38, v12, v38 row_ror:4 row_mask:0xf bank_mask:0x2
    v_add_f32_dpp v39, v16, v39 row_ror:4 row_mask:0xf bank_mask:0x2
    v_add_f32_dpp v36, v23, v22 row_ror:12 row_mask:0xf bank_mask:0x4
    v_add_f32_dpp v37, v27, v26 row_ror:12 row_mask:0xf bank_mask:0x4
    v_add_f32_dpp v38, v28, v31 row_ror:12 row_mask:0xf bank_mask:0x8
    v_add_f32_dpp v39, v32, v35 row_ror:12 row_mask:0xf bank_mask:0x8
    v_add_f32_dpp v36, v20, v36 row_ror:8 row_mask:0xf bank_mask:0x4
    v_add_f32_dpp v37, v24, v37 row_ror:8 row_mask:0xf bank_mask:0x4
    v_add_f32_dpp v38, v29, v38 row_ror:8 row_mask:0xf bank_mask:0x8
    v_add_f32_dpp v39, v33, v39 row_ror:8 row_mask:0xf bank_mask:0x8
    v_add_f32_dpp v36, v21, v36 row_ror:4 row_mask:0xf bank_mask:0x4
    v_add_f32_dpp v37, v25, v37 row_ror:4 row_mask:0xf bank_mask:0x4
    v_add_f32_dpp v38, v30, v38 row_ror:4 row_mask:0xf bank_mask:0x8
    v_add_f32_dpp v39, v34, v39 row_ror:4 row_mask:0xf bank_mask:0x8
    s_nop 0
    v_mov_b32_dpp v36, v38 quad_perm:[0,1,2,3] row_mask:0xf bank_mask:0xa
    v_mov_b32_dpp v37, v39 quad_perm:[0,1,2,3] row_mask:0xf bank_mask:0xa
    v_cvt_pk_bf16_f32 v36, v36, v37
    v_and_b32 v37, 0xffff0000, v36
    v_lshlrev_b32 v36, 16, v36
    v_mul_f32 v36, 0x3db504f3, v36
    v_mul_f32 v37, 0x3db504f3, v37
    v_cvt_pk_bf16_f32 v36, v36, v37
    v_and_b32 v37, 0xffff0000, v36
    v_lshlrev_b32 v36, 16, v36
    v_max_f32 v4, v36, v37
    s_lshl_b32 s42, s3, 11
    v_add_u32 v6, s42, v124
    v_max_f32_dpp v4, v4, v4 row_ror:8 row_mask:0xf bank_mask:0xf
    v_lshlrev_b32 v7, 2, v0
    v_add_u32 v7, 512, v7
    v_max_f32_dpp v4, v4, v4 row_ror:4 row_mask:0xf bank_mask:0xf
    s_mov_b64 exec, s[46:47]
    ds_max_f32 v125, v4 offset:16
    s_mov_b64 exec, -1
    s_mul_i32 s42, s34, 2176
    s_mul_i32 s48, s33, 34816
    s_add_u32 s48, s48, 131072
    s_add_u32 s42, s42, s48
    v_and_b32 v5, 0xf8, v0
    v_lshl_add_u32 v5, v5, 1, v125
    v_lshl_add_u32 v5, v5, 2, s42
    v_mov_b32 v19, s32
    s_branch Lpa6
PA6:
    s_branch LAres
Lpa6:
    s_waitcnt lgkmcnt(0)
    s_barrier
    ds_read_b32 v4, v125 offset:16
    s_xor_b64 s[4:5], s[4:5], s[38:39]
    s_xor_b64 s[6:7], s[6:7], s[38:39]
    s_xor_b64 s[8:9], s[8:9], s[38:39]
    s_xor_b64 s[10:11], s[10:11], s[38:39]
    s_or_b64 s[4:5], s[4:5], s[6:7]
    s_or_b64 s[8:9], s[8:9], s[10:11]
    s_or_b64 s[4:5], s[4:5], s[8:9]
    s_or_b32 s39, s4, s5
    s_mov_b32 s56, 0x0f0f0f0f
    s_mov_b32 s57, 0x0f0f0f0f
    s_mov_b32 s58, 0x00010001
    s_mov_b32 s59, 0x00010001
    s_cmp_eq_u32 s39, 0
    s_cselect_b64 s[60:61], s[56:57], 0
    s_cselect_b64 s[62:63], s[58:59], 0
    s_waitcnt lgkmcnt(0)
    v_sub_f32 v36, v36, v4
    v_sub_f32 v37, v37, v4
    v_mul_f32 v36, 0x3fb8aa3b, v36
    v_mul_f32 v37, 0x3fb8aa3b, v37
    v_exp_f32 v36, v36
    v_exp_f32 v37, v37
    v_mul_f32 v4, 0x3fb8aa3b, v4
    v_cvt_pk_bf16_f32 v38, v36, v37
    v_add_f32 v36, v36, v37
    s_nop 0
    v_mov_b32_dpp v108, v38 quad_perm:[0,1,2,3] row_mask:0xf bank_mask:0x1
    v_mov_b32_dpp v109, v38 row_ror:12 row_mask:0xf bank_mask:0x1
    v_mov_b32_dpp v110, v38 row_ror:8 row_mask:0xf bank_mask:0x1
    v_mov_b32_dpp v111, v38 row_ror:4 row_mask:0xf bank_mask:0x1
    v_add_f32_dpp v36, v36, v36 row_ror:8 row_mask:0xf bank_mask:0xf
    v_mov_b32_dpp v112, v38 row_ror:4 row_mask:0xf bank_mask:0x2
    v_mov_b32_dpp v113, v38 quad_perm:[0,1,2,3] row_mask:0xf bank_mask:0x2
    v_mov_b32_dpp v114, v38 row_ror:12 row_mask:0xf bank_mask:0x2
    v_mov_b32_dpp v115, v38 row_ror:8 row_mask:0xf bank_mask:0x2
    v_add_f32_dpp v36, v36, v36 row_ror:4 row_mask:0xf bank_mask:0xf
    v_mov_b32_dpp v116, v38 row_ror:8 row_mask:0xf bank_mask:0x4
    v_mov_b32_dpp v117, v38 row_ror:4 row_mask:0xf bank_mask:0x4
    v_mov_b32_dpp v118, v38 quad_perm:[0,1,2,3] row_mask:0xf bank_mask:0x4
    v_mov_b32_dpp v119, v38 row_ror:12 row_mask:0xf bank_mask:0x4
    v_mov_b32_dpp v120, v38 row_ror:12 row_mask:0xf bank_mask:0x8
    v_mov_b32_dpp v121, v38 row_ror:8 row_mask:0xf bank_mask:0x8
    v_mov_b32_dpp v122, v38 row_ror:4 row_mask:0xf bank_mask:0x8
    v_mov_b32_dpp v123, v38 quad_perm:[0,1,2,3] row_mask:0xf bank_mask:0x8
    s_mov_b64 exec, s[46:47]
    ds_add_f32 v125, v36 offset:32
    s_mov_b64 exec, -1
    s_cmp_lt_u32 s3, 4
    s_cbranch_scc1 Lyy10
    global_load_dwordx4 v[48:51], v2, s[100:101] nt
    v_add_u32 v2, 0x10000, v2
    global_load_dwordx4 v[52:55], v2, s[100:101] nt
    v_add_u32 v2, 0x10000, v2
    global_load_dwordx4 v[56:59], v2, s[100:101] nt
    v_add_u32 v2, 0x10000, v2
    global_load_dwordx4 v[60:63], v2, s[100:101] nt
    v_add_u32 v2, 0x10000, v2
    global_load_dwordx4 v[64:67], v2, s[100:101] nt
    v_add_u32 v2, 0x10000, v2
    global_load_dwordx4 v[68:71], v2, s[100:101] nt
    s_lshl2_add_u32 s42, s34, s3
    s_sub_u32 s42, s42, 4
    s_and_b32 s43, s42, 1
    s_mul_i32 s43, s43, 0x04040000
    s_add_u32 s49, s43, 0x01000c0c
    s_add_u32 s55, s43, 0x03020c0c
    s_lshr_b32 s43, s42, 1
    s_lshl_b32 s43, s43, 6
    s_add_u32 s43, s43, s48
    v_and_b32 v126, 15, v1
    v_mul_u32_u24 v126, 2176, v126
    v_and_b32 v127, 48, v1
    v_add3_u32 v126, v126, v127, s43
    s_lshr_b32 s43, s34, 2
    s_mul_i32 s43, s43, 2176
    s_and_b32 s42, s42, 15
    s_lshl3_add_u32 s42, s42, s43
    s_add_u32 s42, s42, s48
    s_addk_i32 s42, 2048
    v_mul_u32_u24 v127, 544, v127
    v_add_u32 v127, s42, v127
    v_mov_b32 v39, s32
    s_branch Lyy10
PA2:
    s_branch LAres
Lyy10:
    s_cmp_lt_u32 s3, 4
    s_waitcnt vmcnt(6)
    v_perm_b32 v72, v44, v40, s36
    v_perm_b32 v88, v46, v42, s36
    v_perm_b32 v76, v44, v40, s37
    v_perm_b32 v92, v46, v42, s37
    v_perm_b32 v80, v45, v41, s36
    v_perm_b32 v96, v47, v43, s36
    v_perm_b32 v84, v45, v41, s37
    v_perm_b32 v100, v47, v43, s37
    s_waitcnt vmcnt(4)
    v_perm_b32 v73, v52, v48, s36
    v_perm_b32 v89, v54, v50, s36
    v_perm_b32 v77, v52, v48, s37
    v_perm_b32 v93, v54, v50, s37
    v_perm_b32 v81, v53, v49, s36
    v_perm_b32 v97, v55, v51, s36
    v_perm_b32 v85, v53, v49, s37
    v_perm_b32 v101, v55, v51, s37
    s_waitcnt vmcnt(2)
    v_perm_b32 v74, v60, v56, s36
    v_perm_b32 v90, v62, v58, s36
    v_perm_b32 v78, v60, v56, s37
    v_perm_b32 v94, v62, v58, s37
    v_perm_b32 v82, v61, v57, s36
    v_perm_b32 v98, v63, v59, s36
    v_perm_b32 v86, v61, v57, s37
    v_perm_b32 v102, v63, v59, s37
    s_waitcnt vmcnt(0)
    v_perm_b32 v75, v68, v64, s36
    v_perm_b32 v91, v70, v66, s36
    v_perm_b32 v79, v68, v64, s37
    v_perm_b32 v95, v70, v66, s37
    v_perm_b32 v83, v69, v65, s36
    v_perm_b32 v99, v71, v67, s36
    v_perm_b32 v87, v69, v65, s37
    v_perm_b32 v103, v71, v67, s37
    v_mfma_f32_16x16x32_bf16 v[8:11], v[108:111], v[72:75], 0
    v_mfma_f32_16x16x32_bf16 v[12:15], v[108:111], v[88:91], 0
    v_mfma_f32_16x16x32_bf16 v[8:11], v[112:115], v[76:79], v[8:11]
    v_mfma_f32_16x16x32_bf16 v[12:15], v[112:115], v[92:95], v[12:15]
    v_mfma_f32_16x16x32_bf16 v[8:11], v[116:119], v[80:83], v[8:11]
    v_mfma_f32_16x16x32_bf16 v[12:15], v[116:119], v[96:99], v[12:15]
    v_mfma_f32_16x16x32_bf16 v[8:11], v[120:123], v[84:87], v[8:11]
    v_mfma_f32_16x16x32_bf16 v[12:15], v[120:123], v[100:103], v[12:15]
    s_nop 6
    ds_write_b128 v6, v[8:11] offset:1536
    ds_write_b128 v6, v[12:15] offset:2560
    s_cbranch_scc1 LNW
    s_setprio 1
    s_waitcnt lgkmcnt(0)
    s_barrier
    ds_read_b32 v18, v125 offset:32
    ds_read2st64_b32 v[16:17], v7 offset0:0 offset1:4
    ds_read2st64_b32 v[20:21], v7 offset0:8 offset1:12
    ds_read2st64_b32 v[22:23], v7 offset0:16 offset1:20
    ds_read2st64_b32 v[24:25], v7 offset0:24 offset1:28
    ds_read2st64_b32 v[26:27], v7 offset0:32 offset1:36
    ds_read2st64_b32 v[28:29], v7 offset0:40 offset1:44
    ds_read2st64_b32 v[30:31], v7 offset0:48 offset1:52
    ds_read2st64_b32 v[32:33], v7 offset0:56 offset1:60
    s_waitcnt lgkmcnt(8)
    v_rcp_f32 v34, v18
    v_log_f32 v18, v18
    s_waitcnt lgkmcnt(6)
    v_pk_add_f32 v[16:17], v[16:17], v[20:21]
    v_add_f32 v18, v18, v4
    s_waitcnt lgkmcnt(4)
    v_pk_add_f32 v[22:23], v[22:23], v[24:25]
    v_pk_add_f32 v[16:17], v[16:17], v[22:23]
    s_waitcnt lgkmcnt(2)
    v_pk_add_f32 v[26:27], v[26:27], v[28:29]
    v_pk_add_f32 v[16:17], v[16:17], v[26:27]
    s_waitcnt lgkmcnt(0)
    v_pk_add_f32 v[30:31], v[30:31], v[32:33]
    v_pk_add_f32 v[16:17], v[16:17], v[30:31]
    v_pk_mul_f32 v[16:17], v[16:17], v[34:35] op_sel_hi:[1,0]
    v_cvt_pk_bf16_f32 v16, v16, v17
    s_nop 1
    v_mov_b32_dpp v17, v16 row_shl:4 row_mask:0xf bank_mask:0xf
    s_mov_b64 exec, s[60:61]
    global_store_dwordx4 v5, v[16:19], s[30:31]
    s_cbranch_execz Lfar11
Lsd12:
    s_mov_b64 exec, -1
    global_load_dwordx4 v[40:43], v126, s[30:31] sc1
    s_mov_b32 s50, 0x0c04000c
    s_mov_b32 s51, 0x0402010c
    s_mov_b32 s52, 0x07060501
    s_mov_b32 s53, 0x07060502
    s_mov_b32 s54, 0x07060503
    s_lshl_b32 s42, s34, 7
    s_mul_i32 s43, s33, 2048
    s_add_u32 s43, s43, 671744
    s_add_u32 s43, s43, s42
    v_and_b32 v2, 7, v1
    v_lshlrev_b32 v2, 4, v2
    v_lshrrev_b32 v3, 3, v1
    v_mul_u32_u24 v3, 16640, v3
    v_add3_u32 v3, v3, v2, s43
    v_mov_b32 v27, s32
    s_mul_i32 s42, s33, 8
    s_bfm_b64 s[44:45], 8, s42
    s_cmp_eq_u32 s39, 0
    s_cselect_b64 s[44:45], s[44:45], 0
    s_andn2_b64 s[42:43], -1, s[44:45]
    s_branch Lpoll14
PA3:
    s_branch PA4
Lretry13:
    s_mov_b64 exec, vcc
    global_load_dwordx4 v[40:43], v126, s[30:31] sc1
    s_mov_b64 exec, -1
    s_sub_u32 s35, s35, 1
    s_cbranch_scc1 Lexit
Lpoll14:
    s_waitcnt vmcnt(0)
    v_cmp_ne_u32 vcc, s32, v43
    v_max_f32_dpp v12, v42, v42 row_ror:8 row_mask:0xf bank_mask:0xf
    v_perm_b32 v8, v41, v40, s49
    v_perm_b32 v9, v41, v40, s55
    v_max_f32_dpp v12, v12, v12 row_ror:4 row_mask:0xf bank_mask:0xf
    s_nop 0
    s_cbranch_vccnz Lretry13
    v_max_f32_dpp v12, v12, v12 row_ror:2 row_mask:0xf bank_mask:0xf
    s_nop 1
    v_max_f32_dpp v12, v12, v12 row_ror:1 row_mask:0xf bank_mask:0xf
    v_sub_f32 v10, v42, v12
    v_exp_f32 v10, v10
    s_nop 0
    v_pk_mul_f32 v[8:9], v[8:9], v[10:11] op_sel_hi:[1,0]
    v_add_f32_dpp v10, v10, v10 row_ror:8 row_mask:0xf bank_mask:0xf
    s_nop 0
    v_add_f32_dpp v8, v8, v8 row_ror:8 row_mask:0xf bank_mask:0xf
    v_add_f32_dpp v9, v9, v9 row_ror:8 row_mask:0xf bank_mask:0xf
    v_add_f32_dpp v10, v10, v10 row_ror:4 row_mask:0xf bank_mask:0xf
    v_add_f32_dpp v8, v8, v8 row_ror:4 row_mask:0xf bank_mask:0xf
    v_add_f32_dpp v9, v9, v9 row_ror:4 row_mask:0xf bank_mask:0xf
    v_add_f32_dpp v10, v10, v10 row_ror:2 row_mask:0xf bank_mask:0xf
    v_add_f32_dpp v8, v8, v8 row_ror:2 row_mask:0xf bank_mask:0xf
    v_add_f32_dpp v9, v9, v9 row_ror:2 row_mask:0xf bank_mask:0xf
    v_add_f32_dpp v10, v10, v10 row_ror:1 row_mask:0xf bank_mask:0xf
    v_rcp_f32 v10, v10
    v_add_f32_dpp v8, v8, v8 row_ror:1 row_mask:0xf bank_mask:0xf
    v_add_f32_dpp v9, v9, v9 row_ror:1 row_mask:0xf bank_mask:0xf
    v_pk_mul_f32 v[8:9], v[8:9], v[10:11] op_sel_hi:[1,0]
    v_cvt_pk_bf16_f32 v38, v8, v9
    s_mov_b64 exec, s[62:63]
    global_store_dwordx2 v127, v[38:39], s[30:31]
    s_cbranch_execz Lfar15
Lsd16:
    s_barrier
    s_mov_b64 exec, -1
    s_cmp_lg_u32 s3, 4
    s_cbranch_scc1 LAend
    s_barrier
    ds_read_b128 v[8:11], v2 offset:17920
    ds_read_b128 v[12:15], v2 offset:18048
    ds_read_b128 v[16:19], v2 offset:18176
    ds_read_b128 v[20:23], v2 offset:18304
    s_waitcnt lgkmcnt(2)
    v_pk_add_f32 v[8:9], v[8:9], v[12:13]
    v_pk_add_f32 v[10:11], v[10:11], v[14:15]
    s_waitcnt lgkmcnt(1)
    v_pk_add_f32 v[8:9], v[8:9], v[16:17]
    v_pk_add_f32 v[10:11], v[10:11], v[18:19]
    s_waitcnt lgkmcnt(0)
    v_pk_add_f32 v[10:11], v[10:11], v[22:23]
    v_pk_add_f32 v[8:9], v[8:9], v[20:21]
    v_perm_b32 v24, v8, v11, s52
    v_perm_b32 v25, v9, v11, s53
    v_perm_b32 v26, v10, v11, s54
    s_mov_b64 exec, s[42:43]
    global_store_dwordx4 v3, v[24:27], s[30:31] sc1
    s_mov_b64 exec, s[44:45]
    s_cbranch_execz Low17
    global_store_dwordx4 v3, v[24:27], s[30:31]
Low17:
    s_mov_b64 exec, -1
LAend:
    s_endpgm
Lfar11:
    s_mov_b64 exec, s[56:57]
    global_store_dwordx4 v5, v[16:19], s[30:31] sc1
    s_branch Lsd12
Lfar15:
    s_mov_b64 exec, s[58:59]
    global_store_dwordx2 v127, v[38:39], s[30:31] sc1
    s_branch Lsd16
.p2align 12
PA4:
    s_branch LAres
LNW:
    s_lshl2_add_u32 s42, s33, s3
    s_lshl_b32 s42, s42, 17
    s_lshl_b32 s43, s34, 6
    s_add_u32 s42, s42, s43
    s_addk_i32 s42, 4096
    v_and_b32 v4, 15, v1
    v_lshrrev_b32 v5, 4, v1
    v_lshlrev_b32 v3, 10, v5
    v_lshl_add_u32 v3, v4, 2, v3
    v_add_u32 v3, s42, v3
    s_movk_i32 s44, 0x2000
    global_load_dword v40, v3, s[0:1] offset:-4096
    global_load_dword v41, v3, s[0:1] offset:0
    v_add_u32 v3, s44, v3
    global_load_dword v42, v3, s[0:1] offset:-4096
    global_load_dword v43, v3, s[0:1] offset:0
    v_add_u32 v3, s44, v3
    global_load_dword v44, v3, s[0:1] offset:-4096
    global_load_dword v45, v3, s[0:1] offset:0
    v_add_u32 v3, s44, v3
    global_load_dword v46, v3, s[0:1] offset:-4096
    global_load_dword v47, v3, s[0:1] offset:0
    v_add_u32 v3, s44, v3
    global_load_dword v48, v3, s[0:1] offset:-4096
    global_load_dword v49, v3, s[0:1] offset:0
    v_add_u32 v3, s44, v3
    global_load_dword v50, v3, s[0:1] offset:-4096
    global_load_dword v51, v3, s[0:1] offset:0
    v_add_u32 v3, s44, v3
    global_load_dword v52, v3, s[0:1] offset:-4096
    global_load_dword v53, v3, s[0:1] offset:0
    v_add_u32 v3, s44, v3
    global_load_dword v54, v3, s[0:1] offset:-4096
    global_load_dword v55, v3, s[0:1] offset:0
    v_add_u32 v3, s44, v3
    s_waitcnt lgkmcnt(0)
    s_barrier
    v_bfe_u32 v2, v1, 3, 2
    v_lshl_add_u32 v2, s3, 2, v2
    v_mul_u32_u24 v2, 2176, v2
    v_and_b32 v5, 7, v1
    v_lshl_add_u32 v2, v5, 3, v2
    v_and_b32 v5, 32, v1
    v_lshl_add_u32 v2, v5, 1, v2
    s_add_u32 s42, s48, 2048
    v_add_u32 v2, s42, v2
    s_lshr_b32 s42, s33, 2
    v_xor_b32 v6, s42, v4
    s_lshl_b32 s42, s3, 7
    v_lshl_add_u32 v6, v6, 3, s42
    v_and_b32 v7, 1, v0
    v_mul_u32_u24 v7, 0xaaaa, v7
    v_add_u32 v7, 0x4444, v7
    v_mov_b64 v[16:17], 0
    v_mov_b64 v[18:19], 0
    v_mov_b64 v[20:21], 0
    v_mov_b64 v[22:23], 0
    v_mov_b64 v[24:25], 0
    v_mov_b64 v[26:27], 0
    v_mov_b64 v[28:29], 0
    v_mov_b64 v[30:31], 0
    s_waitcnt vmcnt(8)
    v_perm_b32 v72, v41, v40, s36
    v_perm_b32 v88, v41, v40, s37
    v_perm_b32 v73, v43, v42, s36
    v_perm_b32 v89, v43, v42, s37
    v_perm_b32 v80, v45, v44, s36
    v_perm_b32 v96, v45, v44, s37
    v_perm_b32 v81, v47, v46, s36
    v_perm_b32 v97, v47, v46, s37
    s_waitcnt vmcnt(4)
    v_perm_b32 v74, v49, v48, s36
    v_perm_b32 v90, v49, v48, s37
    v_perm_b32 v75, v51, v50, s36
    v_perm_b32 v91, v51, v50, s37
    s_waitcnt vmcnt(0)
    v_perm_b32 v82, v53, v52, s36
    v_perm_b32 v98, v53, v52, s37
    v_perm_b32 v83, v55, v54, s36
    v_perm_b32 v99, v55, v54, s37
    s_barrier
    global_load_dword v56, v3, s[0:1] offset:-4096
    global_load_dword v57, v3, s[0:1] offset:0
    v_add_u32 v3, s44, v3
    global_load_dword v58, v3, s[0:1] offset:-4096
    global_load_dword v59, v3, s[0:1] offset:0
    v_add_u32 v3, s44, v3
    global_load_dword v60, v3, s[0:1] offset:-4096
    global_load_dword v61, v3, s[0:1] offset:0
    v_add_u32 v3, s44, v3
    global_load_dword v62, v3, s[0:1] offset:-4096
    global_load_dword v63, v3, s[0:1] offset:0
    v_add_u32 v3, s44, v3
    global_load_dword v64, v3, s[0:1] offset:-4096
    global_load_dword v65, v3, s[0:1] offset:0
    v_add_u32 v3, s44, v3
    global_load_dword v66, v3, s[0:1] offset:-4096
    global_load_dword v67, v3, s[0:1] offset:0
    v_add_u32 v3, s44, v3
    global_load_dword v68, v3, s[0:1] offset:-4096
    global_load_dword v69, v3, s[0:1] offset:0
    v_add_u32 v3, s44, v3
    global_load_dword v70, v3, s[0:1] offset:-4096
    global_load_dword v71, v3, s[0:1] offset:0
    global_load_dwordx2 v[8:9], v2, s[30:31] sc1
    s_waitcnt vmcnt(9)
    v_perm_b32 v76, v57, v56, s36
    v_perm_b32 v92, v57, v56, s37
    v_perm_b32 v77, v59, v58, s36
    v_perm_b32 v93, v59, v58, s37
    v_perm_b32 v84, v61, v60, s36
    v_perm_b32 v100, v61, v60, s37
    v_perm_b32 v85, v63, v62, s36
    v_perm_b32 v101, v63, v62, s37
    s_waitcnt vmcnt(5)
    v_perm_b32 v78, v65, v64, s36
    v_perm_b32 v94, v65, v64, s37
    v_perm_b32 v79, v67, v66, s36
    v_perm_b32 v95, v67, v66, s37
    s_waitcnt vmcnt(1)
    v_perm_b32 v86, v69, v68, s36
    v_perm_b32 v102, v69, v68, s37
    v_perm_b32 v87, v71, v70, s36
    v_perm_b32 v103, v71, v70, s37
    s_branch Lpoll19
Lretry18:
    s_mov_b64 exec, vcc
    global_load_dwordx2 v[8:9], v2, s[30:31] sc1
    s_mov_b64 exec, -1
    s_sub_u32 s35, s35, 1
    s_cbranch_scc1 Lexit
Lpoll19:
    s_waitcnt vmcnt(0)
    v_cmp_ne_u32 vcc, s32, v9
    v_mov_b32_dpp v13, v8 row_shl:4 row_mask:0xf bank_mask:0xf
    v_mov_b32_dpp v14, v8 row_shl:8 row_mask:0xf bank_mask:0xf
    v_mov_b32_dpp v15, v8 row_shl:12 row_mask:0xf bank_mask:0xf
    v_mov_b32 v12, v8
    s_nop 0
    s_cbranch_vccnz Lretry18
    v_smfmac_f32_16x16x64_bf16 v[16:19], v[12:15], v[72:79], v7
    v_smfmac_f32_16x16x64_bf16 v[20:23], v[12:15], v[80:87], v7
    v_smfmac_f32_16x16x64_bf16 v[24:27], v[12:15], v[88:95], v7
    v_smfmac_f32_16x16x64_bf16 v[28:31], v[12:15], v[96:103], v7
    s_mov_b64 exec, 0xffff
    s_nop 4
    v_pk_add_f32 v[16:17], v[16:17], v[22:23]
    v_add_f32 v16, v16, v17
    v_pk_add_f32 v[24:25], v[24:25], v[30:31]
    v_add_f32 v17, v24, v25
    ds_write_b64 v6, v[16:17] offset:17920
    s_mov_b64 exec, -1
    s_waitcnt lgkmcnt(0)
    s_barrier
    s_endpgm
PQ5:
    s_cbranch_execz Lexit1
Lload64:
    global_load_dword v9, v4, s[10:11]
    global_load_dword v24, v4, s[14:15]
    global_load_dword v41, v4, s[26:27]
    global_load_dword v56, v4, s[6:7]
    v_add_u32 v4, s50, v4
    global_load_dword v16, v4, s[10:11]
    global_load_dword v25, v4, s[14:15]
    global_load_dword v48, v4, s[26:27]
    global_load_dword v57, v4, s[6:7]
    v_add_u32 v4, s50, v4
    global_load_dword v17, v4, s[10:11]
    global_load_dword v32, v4, s[14:15]
    global_load_dword v49, v4, s[26:27]
    global_load_dword v64, v4, s[6:7]
    v_add_u32 v4, s50, v4
    global_load_dword v10, v4, s[10:11]
    global_load_dword v33, v4, s[14:15]
    global_load_dword v42, v4, s[26:27]
    global_load_dword v65, v4, s[6:7]
    v_add_u32 v4, s50, v4
    global_load_dword v11, v4, s[10:11]
    global_load_dword v26, v4, s[14:15]
    global_load_dword v43, v4, s[26:27]
    global_load_dword v58, v4, s[6:7]
    v_add_u32 v4, s50, v4
    global_load_dword v18, v4, s[10:11]
    global_load_dword v27, v4, s[14:15]
    global_load_dword v50, v4, s[26:27]
    global_load_dword v59, v4, s[6:7]
    v_add_u32 v4, s50, v4
    global_load_dword v19, v4, s[10:11]
    global_load_dword v34, v4, s[14:15]
    global_load_dword v51, v4, s[26:27]
    global_load_dword v66, v4, s[6:7]
    v_add_u32 v4, s50, v4
    global_load_dword v12, v4, s[10:11]
    global_load_dword v35, v4, s[14:15]
    global_load_dword v44, v4, s[26:27]
    global_load_dword v67, v4, s[6:7]
    v_add_u32 v4, s51, v4
    v_mov_b64 v[76:77], 0
    v_mov_b64 v[78:79], 0
    v_mov_b64 v[80:81], 0
    v_mov_b64 v[82:83], 0
    v_mov_b64 v[84:85], 0
    v_mov_b64 v[86:87], 0
    v_mov_b64 v[88:89], 0
    v_mov_b64 v[90:91], 0
    s_swappc_b64 s[60:61], s[60:61]
    s_waitcnt vmcnt(24)
    v_perm_b32 v8, v24, v9, s36
    v_perm_b32 v24, v24, v9, s37
    v_perm_b32 v40, v56, v41, s36
    v_perm_b32 v56, v56, v41, s37
    v_perm_b32 v9, v25, v16, s36
    v_perm_b32 v25, v25, v16, s37
    v_perm_b32 v41, v57, v48, s36
    v_perm_b32 v57, v57, v48, s37
    global_load_dword v13, v4, s[10:11]
    global_load_dword v28, v4, s[14:15]
    global_load_dword v45, v4, s[26:27]
    global_load_dword v60, v4, s[6:7]
    v_add_u32 v4, s50, v4
    global_load_dword v20, v4, s[10:11]
    global_load_dword v29, v4, s[14:15]
    global_load_dword v52, v4, s[26:27]
    global_load_dword v61, v4, s[6:7]
    v_add_u32 v4, s50, v4
    s_waitcnt vmcnt(24)
    v_perm_b32 v16, v32, v17, s36
    v_perm_b32 v32, v32, v17, s37
    v_perm_b32 v48, v64, v49, s36
    v_perm_b32 v64, v64, v49, s37
    v_perm_b32 v17, v33, v10, s36
    v_perm_b32 v33, v33, v10, s37
    v_perm_b32 v49, v65, v42, s36
    v_perm_b32 v65, v65, v42, s37
    global_load_dword v21, v4, s[10:11]
    global_load_dword v36, v4, s[14:15]
    global_load_dword v53, v4, s[26:27]
    global_load_dword v68, v4, s[6:7]
    v_add_u32 v4, s50, v4
    global_load_dword v14, v4, s[10:11]
    global_load_dword v37, v4, s[14:15]
    global_load_dword v46, v4, s[26:27]
    global_load_dword v69, v4, s[6:7]
    v_add_u32 v4, s50, v4
    s_waitcnt vmcnt(24)
    v_perm_b32 v10, v26, v11, s36
    v_perm_b32 v26, v26, v11, s37
    v_perm_b32 v42, v58, v43, s36
    v_perm_b32 v58, v58, v43, s37
    v_perm_b32 v11, v27, v18, s36
    v_perm_b32 v27, v27, v18, s37
    v_perm_b32 v43, v59, v50, s36
    v_perm_b32 v59, v59, v50, s37
    global_load_dword v15, v4, s[10:11]
    global_load_dword v30, v4, s[14:15]
    global_load_dword v47, v4, s[26:27]
    global_load_dword v62, v4, s[6:7]
    v_add_u32 v4, s50, v4
    global_load_dword v22, v4, s[10:11]
    global_load_dword v31, v4, s[14:15]
    global_load_dword v54, v4, s[26:27]
    global_load_dword v63, v4, s[6:7]
    v_add_u32 v4, s50, v4
    s_waitcnt vmcnt(24)
    v_perm_b32 v18, v34, v19, s36
    v_perm_b32 v34, v34, v19, s37
    v_perm_b32 v50, v66, v51, s36
    v_perm_b32 v66, v66, v51, s37
    v_perm_b32 v19, v35, v12, s36
    v_perm_b32 v35, v35, v12, s37
    v_perm_b32 v51, v67, v44, s36
    v_perm_b32 v67, v67, v44, s37
    global_load_dword v23, v4, s[10:11]
    global_load_dword v38, v4, s[14:15]
    global_load_dword v55, v4, s[26:27]
    global_load_dword v70, v4, s[6:7]
    v_add_u32 v4, s50, v4
    global_load_dword v72, v4, s[10:11]
    global_load_dword v39, v4, s[14:15]
    global_load_dword v73, v4, s[26:27]
    global_load_dword v71, v4, s[6:7]
    s_setpc_b64 s[60:61]
LFH:
    s_mov_b64 exec, -1
    s_waitcnt lgkmcnt(0)
    s_load_dword s32, s[30:31], 0
    s_mov_b32 s35, 0x100000
    s_mov_b32 s36, 0x05040100
    s_mov_b32 s37, 0x07060302
    s_and_b32 s34, s34, 7
    s_lshl3_add_u32 s40, s33, s34
    s_lshl_b32 s62, s3, 3
    s_xor_b32 s40, s40, 32
    v_bfe_u32 v2, v1, 3, 1
    v_bfe_u32 v3, v1, 4, 1
    v_lshl_add_u32 v5, v2, 1, v3
    v_and_b32 v6, 3, v1
    v_lshl_add_u32 v6, v5, 2, v6
    v_lshlrev_b32 v6, 5, v6
    v_lshl_add_u32 v5, s40, 2, v5
    v_lshlrev_b32 v7, 2, v5
    v_bfe_u32 v4, v1, 2, 1
    v_cmp_ne_u32 s[46:47], v4, v3
    s_mul_i32 s42, s33, 12544
    s_add_u32 s42, s42, 11264
    v_lshl_add_u32 v3, v5, 3, s42
    s_mul_i32 s42, s33, 16640
    s_add_u32 s42, s42, 671744
    v_lshl_add_u32 v2, s40, 1, v2
    v_lshl_add_u32 v2, v2, 4, s42
    v_and_b32 v4, 7, v1
    v_lshl_add_u32 v4, v4, 11, v2
    s_waitcnt lgkmcnt(0)
    s_mul_i32 s32, s32, 0x9e3779b1
    s_add_u32 s32, s32, 0x7f4a7c15
    s_mov_b32 s50, 0x0c04000c
    s_mov_b32 s51, 0x0402010c
    s_mov_b32 s52, 0x07060501
    s_mov_b32 s53, 0x07060502
    s_mov_b32 s54, 0x07060503
    s_barrier
    s_barrier
    s_barrier
    s_barrier
    s_barrier
    s_barrier
    s_barrier
    global_load_dword v8, v7, s[4:5]
    s_branch Lpoll21
Lretry20:
Lpoll21:
    global_load_dwordx2 v[10:11], v3, s[30:31] offset:-3072 sc1
    global_load_dwordx2 v[12:13], v3, s[30:31] offset:3072 sc1
    global_load_dwordx4 v[16:19], v4, s[30:31] sc1
    s_sub_u32 s35, s35, 1
    s_cbranch_scc1 Lexit
    s_waitcnt vmcnt(0)
    v_bitop3_b32 v14, v11, s32, v13 bitop3:0x7e
    v_bitop3_b32 v14, v19, s32, v14 bitop3:0xbe
    v_cmp_ne_u32 vcc, 0, v14
    s_cbranch_vccnz Lretry20
    v_and_b32 v9, 0xffff0000, v8
    v_lshlrev_b32 v8, 16, v8
    v_and_b32 v11, 0xffff0000, v10
    v_lshlrev_b32 v10, 16, v10
    v_and_b32 v13, 0xffff0000, v12
    v_lshlrev_b32 v12, 16, v12
    v_perm_b32 v19, v17, v16, s50
    v_perm_b32 v19, v18, v19, s51
    v_cndmask_b32 v14, v16, v18, s[46:47]
    v_cndmask_b32 v15, v17, v19, s[46:47]
    s_nop 0
    v_add_f32_dpp v14, v14, v14 quad_perm:[1,0,3,2] row_mask:0xf bank_mask:0xf
    v_add_f32_dpp v15, v15, v15 quad_perm:[1,0,3,2] row_mask:0xf bank_mask:0xf
    s_nop 0
    v_add_f32_dpp v14, v14, v14 quad_perm:[2,3,0,1] row_mask:0xf bank_mask:0xf
    v_add_f32_dpp v15, v15, v15 quad_perm:[2,3,0,1] row_mask:0xf bank_mask:0xf
    s_nop 0
    v_add_f32_dpp v14, v14, v14 row_half_mirror row_mask:0xf bank_mask:0xf
    v_add_f32_dpp v15, v15, v15 row_half_mirror row_mask:0xf bank_mask:0xf
    v_cvt_pk_bf16_f32 v14, v14, v15
    v_and_b32 v15, 0xffff0000, v14
    v_lshlrev_b32 v14, 16, v14
    v_pk_mul_f32 v[14:15], v[14:15], v[10:11]
    v_cvt_pk_bf16_f32 v14, v14, v15
    v_and_b32 v15, 0xffff0000, v14
    v_lshlrev_b32 v14, 16, v14
    v_pk_add_f32 v[14:15], v[14:15], v[8:9]
    v_cvt_pk_bf16_f32 v14, v14, v15
    v_and_b32 v15, 0xffff0000, v14
    v_lshlrev_b32 v14, 16, v14
    s_mov_b64 exec, 0x0f0f0f0f
    s_cmp_lg_u32 s40, 0
    s_cbranch_scc1 Ldend
    v_mov_b32 v2, 0
    v_mov_b32 v3, s32
    global_store_dword v2, v3, s[30:31] sc1
Ldend:
    s_barrier
    ds_read_b128 v[16:19], v6 offset:768
    ds_read_b128 v[20:23], v6 offset:784
    s_waitcnt lgkmcnt(0)
    v_pk_add_f32 v[16:17], v[16:17], v[18:19]
    v_pk_add_f32 v[20:21], v[20:21], v[22:23]
    v_pk_add_f32 v[16:17], v[16:17], v[20:21]
    s_nop 0
    s_nop 0
    v_add_f32_dpp v16, v16, v16 quad_perm:[1,0,3,2] row_mask:0xf bank_mask:0xf
    v_add_f32_dpp v17, v17, v17 quad_perm:[1,0,3,2] row_mask:0xf bank_mask:0xf
    s_nop 0
    v_add_f32_dpp v16, v16, v16 quad_perm:[2,3,0,1] row_mask:0xf bank_mask:0xf
    v_add_f32_dpp v17, v17, v17 quad_perm:[2,3,0,1] row_mask:0xf bank_mask:0xf
    v_pk_fma_f32 v[16:17], v[16:17], v[12:13], v[14:15]
    v_cvt_pk_bf16_f32 v16, v16, v17
    global_store_dword v7, v16, s[26:27]
    s_endpgm
.p2align 12
LM:
    s_mov_b32 s35, 0x100000
    s_mov_b32 s36, 0x05040100
    s_mov_b32 s37, 0x07060302
    s_and_b32 s34, s34, 7
    s_lshl3_add_u32 s40, s33, s34
    s_lshl_b32 s62, s3, 3
    v_lshrrev_b32 v4, 1, v0
    v_and_b32 v5, 1, v0
    v_mul_u32_u24 v4, 24576, v4
    v_lshl_add_u32 v4, v5, 4, v4
    s_lshl_b32 s42, s40, 5
    s_addk_i32 s42, 3072
    v_add_u32 v4, s42, v4
    v_add_u32 v3, 12288, v4
    v_lshlrev_b32 v6, 2, v0
    s_lshl_b32 s42, s34, 6
    v_lshrrev_b32 v120, 2, v0
    v_add_u32 v120, s42, v120
    v_bfe_u32 v122, v0, 1, 1
    v_mad_u32_u24 v120, v120, 48, v122
    s_lshl_b32 s42, s33, 1
    v_add_lshl_u32 v120, v120, s42, 7
    s_waitcnt lgkmcnt(0)
    global_load_dword v6, v6, s[22:23]
    global_load_dwordx4 v[8:11], v4, s[24:25] offset:-3072
    global_load_dwordx4 v[12:15], v4, s[24:25] offset:3072
    global_load_dwordx4 v[16:19], v3, s[24:25] offset:-3072
    global_load_dwordx4 v[20:23], v3, s[24:25] offset:3072
    s_load_dword s32, s[30:31], 0
    s_getreg_b32 s38, hwreg(HW_REG_XCC_ID, 0, 4)
    s_or_b32 s38, s38, 0x80
    s_mul_i32 s38, s38, 0x01010101
    v_and_b32 v126, 7, v0
    v_lshlrev_b32 v126, 2, v126
    v_lshl_add_u32 v126, s33, 5, v126
    v_or_b32 v126, 16, v126
    global_load_dword v127, v126, s[28:29] sc1
    v_mov_b32 v40, 0
    v_mov_b32 v41, 0
    v_mov_b32 v42, 0
    v_mov_b32 v43, 0
    v_mov_b32 v44, 0
    v_mov_b32 v45, 0
    v_mov_b32 v46, 0
    v_mov_b32 v47, 0
    v_lshrrev_b32 v48, 4, v1
    v_lshl_add_u32 v48, v48, 1, v5
    v_lshl_add_u32 v81, v48, 5, s62
    v_and_b32 v48, 1, v1
    v_bfe_u32 v49, v1, 1, 1
    v_lshl_add_u32 v48, v48, 2, v49
    v_lshlrev_b32 v82, 5, v48
    v_and_b32 v48, 3, v1
    v_bfe_u32 v49, v1, 2, 3
    v_mul_u32_u24 v49, 8448, v49
    v_lshl_add_u32 v83, v48, 4, v49
    s_mul_i32 s42, s40, 128
    s_add_u32 s42, s42, 950272
    v_add_u32 v83, s42, v83
    s_waitcnt vmcnt(5)
    v_and_b32 v49, 0xffff0000, v6
    v_lshlrev_b32 v48, 16, v6
    v_mul_f32 v50, 0xbfb8aa3b, v48
    v_mul_f32 v51, 0xbfb8aa3b, v49
    v_exp_f32 v50, v50
    v_exp_f32 v51, v51
    v_add_f32 v50, 1.0, v50
    v_add_f32 v51, 1.0, v51
    v_rcp_f32 v50, v50
    v_rcp_f32 v51, v51
    v_mul_f32 v48, v48, v50
    v_mul_f32 v49, v49, v51
    v_cvt_pk_bf16_f32 v80, v48, v49
    s_waitcnt lgkmcnt(0)
    s_mul_i32 s32, s32, 0x9e3779b1
    s_add_u32 s32, s32, 0x7f4a7c15
    v_mov_b32 v85, s32
    v_mov_b32 v87, s32
    s_waitcnt vmcnt(3)
    v_perm_b32 v48, v12, v8, s36
    v_perm_b32 v49, v12, v8, s37
    v_perm_b32 v50, v13, v9, s36
    v_perm_b32 v51, v13, v9, s37
    v_perm_b32 v52, v14, v10, s36
    v_perm_b32 v53, v14, v10, s37
    v_perm_b32 v54, v15, v11, s36
    v_perm_b32 v55, v15, v11, s37
    v_dot2c_f32_bf16_dpp v40, v80, v48 quad_perm:[0,0,2,2] row_mask:0xf bank_mask:0xf
    v_dot2c_f32_bf16_dpp v41, v80, v49 quad_perm:[0,0,2,2] row_mask:0xf bank_mask:0xf
    v_dot2c_f32_bf16_dpp v42, v80, v50 quad_perm:[0,0,2,2] row_mask:0xf bank_mask:0xf
    v_dot2c_f32_bf16_dpp v43, v80, v51 quad_perm:[0,0,2,2] row_mask:0xf bank_mask:0xf
    v_dot2c_f32_bf16_dpp v44, v80, v52 quad_perm:[0,0,2,2] row_mask:0xf bank_mask:0xf
    v_dot2c_f32_bf16_dpp v45, v80, v53 quad_perm:[0,0,2,2] row_mask:0xf bank_mask:0xf
    v_dot2c_f32_bf16_dpp v46, v80, v54 quad_perm:[0,0,2,2] row_mask:0xf bank_mask:0xf
    v_dot2c_f32_bf16_dpp v47, v80, v55 quad_perm:[0,0,2,2] row_mask:0xf bank_mask:0xf
    s_waitcnt vmcnt(1)
    v_perm_b32 v56, v20, v16, s36
    v_perm_b32 v57, v20, v16, s37
    v_perm_b32 v58, v21, v17, s36
    v_perm_b32 v59, v21, v17, s37
    v_perm_b32 v60, v22, v18, s36
    v_perm_b32 v61, v22, v18, s37
    v_perm_b32 v62, v23, v19, s36
    v_perm_b32 v63, v23, v19, s37
    v_dot2c_f32_bf16_dpp v40, v80, v56 quad_perm:[1,1,3,3] row_mask:0xf bank_mask:0xf
    v_dot2c_f32_bf16_dpp v41, v80, v57 quad_perm:[1,1,3,3] row_mask:0xf bank_mask:0xf
    v_dot2c_f32_bf16_dpp v42, v80, v58 quad_perm:[1,1,3,3] row_mask:0xf bank_mask:0xf
    v_dot2c_f32_bf16_dpp v43, v80, v59 quad_perm:[1,1,3,3] row_mask:0xf bank_mask:0xf
    v_dot2c_f32_bf16_dpp v44, v80, v60 quad_perm:[1,1,3,3] row_mask:0xf bank_mask:0xf
    v_dot2c_f32_bf16_dpp v45, v80, v61 quad_perm:[1,1,3,3] row_mask:0xf bank_mask:0xf
    v_dot2c_f32_bf16_dpp v46, v80, v62 quad_perm:[1,1,3,3] row_mask:0xf bank_mask:0xf
    v_dot2c_f32_bf16_dpp v47, v80, v63 quad_perm:[1,1,3,3] row_mask:0xf bank_mask:0xf
    s_nop 1
    v_permlane32_swap_b32 v40, v44
    v_permlane32_swap_b32 v41, v45
    v_permlane32_swap_b32 v42, v46
    v_permlane32_swap_b32 v43, v47
    v_add_f32 v40, v40, v44
    v_add_f32 v42, v42, v46
    v_add_f32 v41, v41, v45
    v_add_f32 v43, v43, v47
    v_permlane16_swap_b32 v40, v42
    s_nop 0
    v_permlane16_swap_b32 v41, v43
    v_add_f32 v40, v40, v42
    v_add_f32 v41, v41, v43
    s_nop 0
    v_add_f32_dpp v40, v40, v40 row_ror:8 row_mask:0xf bank_mask:0xf
    v_add_f32_dpp v41, v41, v41 row_ror:8 row_mask:0xf bank_mask:0xf
    s_nop 0
    v_add_f32_dpp v40, v40, v40 row_ror:4 row_mask:0xf bank_mask:0xf
    v_add_f32_dpp v41, v41, v41 row_ror:4 row_mask:0xf bank_mask:0xf
    s_nop 0
    v_add_f32_dpp v40, v40, v40 quad_perm:[2,3,0,1] row_mask:0xf bank_mask:0xf
    v_add_f32_dpp v41, v41, v41 quad_perm:[2,3,0,1] row_mask:0xf bank_mask:0xf
    ds_write_b64 v81, v[40:41] offset:0
    s_waitcnt vmcnt(0)
    v_cmp_ne_u32 vcc, s38, v127
    s_mov_b32 s39, vcc_lo
    s_mov_b32 s48, -1
    s_mov_b32 s49, 0
    s_mul_i32 s44, s33, 4
    s_bfm_b64 s[46:47], 4, s44
    s_cmp_eq_u32 s39, 0
    s_cselect_b64 s[46:47], s[46:47], 0
    s_andn2_b64 s[44:45], s[48:49], s[46:47]
    s_waitcnt lgkmcnt(0)
    s_barrier
    s_cmp_ge_u32 s3, 1
    s_cbranch_scc1 Lnm22
    ds_read_b128 v[48:51], v82 offset:0
    ds_read_b128 v[52:55], v82 offset:16
    ds_read_b128 v[56:59], v82 offset:64
    ds_read_b128 v[60:63], v82 offset:80
    s_mov_b32 exec_hi, 0
    s_waitcnt lgkmcnt(2)
    v_pk_add_f32 v[48:49], v[48:49], v[50:51]
    v_pk_add_f32 v[52:53], v[52:53], v[54:55]
    v_pk_add_f32 v[48:49], v[48:49], v[52:53]
    v_cvt_pk_bf16_f32 v84, v48, v49
    s_waitcnt lgkmcnt(0)
    v_pk_add_f32 v[56:57], v[56:57], v[58:59]
    v_pk_add_f32 v[60:61], v[60:61], v[62:63]
    v_pk_add_f32 v[56:57], v[56:57], v[60:61]
    v_cvt_pk_bf16_f32 v86, v56, v57
    s_mov_b64 exec, s[44:45]
    global_store_dwordx4 v83, v[84:87], s[30:31] sc1
    s_mov_b64 exec, s[46:47]
    s_cbranch_execz Low23
    global_store_dwordx4 v83, v[84:87], s[30:31]
Low23:
    s_mov_b64 exec, -1
    s_mov_b32 exec_hi, -1
Lnm22:
    s_barrier
    s_lshl_b32 s42, s34, 5
    v_xor_b32 v123, s42, v0
    s_lshl_b32 s42, s40, 7
    s_mul_i32 s43, s33, 12544
    s_add_u32 s43, s43, 8192
    s_add_u32 s43, s43, s42
    v_mov_b32 v120, s43
    global_load_dword v121, v120, s[30:31] sc1
    s_mul_i32 s42, s34, 896
    s_mul_i32 s43, s33, 7424
    s_add_u32 s43, s43, 806912
    s_add_u32 s43, s43, s42
    v_lshrrev_b32 v120, 5, v0
    v_min_u32 v120, 6, v120
    v_lshl_add_u32 v120, v120, 7, s43
    global_load_dword v121, v120, s[30:31] sc1
    s_lshl_b32 s42, s33, 24
    s_lshl_b32 s43, s34, 14
    s_add_u32 s42, s42, s43
    s_add_u32 s42, s42, 16384000
    v_lshrrev_b32 v120, 1, v123
    v_lshl_add_u32 v120, v120, 7, s42
    global_load_dword v121, v120, s[8:9]
    s_lshl_b32 s42, s33, 24
    s_lshl_b32 s43, s34, 15
    s_add_u32 s42, s42, s43
    s_add_u32 s42, s42, 16515072
    v_lshl_add_u32 v120, v123, 7, s42
    global_load_dword v121, v120, s[8:9]
    s_lshl_b32 s42, s34, 6
    v_lshrrev_b32 v120, 2, v0
    v_add_u32 v120, s42, v120
    v_and_b32 v122, 3, v0
    v_mad_u32_u24 v120, v120, 48, v122
    s_lshl2_add_u32 s42, s33, 16
    v_add_lshl_u32 v120, v120, s42, 7
    global_load_dword v121, v120, s[24:25]
PM1:
    s_cbranch_execz Lexit1
    v_lshrrev_b32 v4, 2, v0
    v_and_b32 v5, 3, v0
    v_mul_u32_u24 v4, 49152, v4
    v_lshl_add_u32 v4, v5, 4, v4
    s_lshl_b32 s42, s40, 6
    s_addk_i32 s42, 5120
    v_add_u32 v4, s42, v4
    s_movk_i32 s42, 12288
    global_load_dwordx4 v[8:11], v4, s[24:25] offset:-3072
    global_load_dwordx4 v[12:15], v4, s[24:25] offset:3072
    v_add_u32 v4, s42, v4
    global_load_dwordx4 v[16:19], v4, s[24:25] offset:-3072
    global_load_dwordx4 v[20:23], v4, s[24:25] offset:3072
    v_add_u32 v4, s42, v4
    global_load_dwordx4 v[24:27], v4, s[24:25] offset:-3072
    global_load_dwordx4 v[28:31], v4, s[24:25] offset:3072
    v_add_u32 v4, s42, v4
    global_load_dwordx4 v[32:35], v4, s[24:25] offset:-3072
    global_load_dwordx4 v[36:39], v4, s[24:25] offset:3072
    s_barrier
    s_lshl_b32 s42, s34, 5
    v_xor_b32 v123, s42, v0
    s_cmp_eq_u32 s33, 7
    s_cselect_b64 exec, 1, -1
    s_lshr_b32 s42, s3, 1
    s_lshl1_add_u32 s42, s34, s42
    s_and_b32 s43, s42, 12
    s_add_u32 s42, s42, s43
    s_lshl_b32 s42, s42, 4
    s_addk_i32 s42, 64
    v_lshrrev_b32 v120, 2, v1
    v_add_u32 v120, s42, v120
    v_bfe_u32 v122, v1, 0, 2
    v_mad_u32_u24 v120, v120, 28, v122
    s_min_u32 s42, s33, 6
    s_lshl_b32 s42, s42, 2
    v_add_lshl_u32 v120, v120, s42, 7
    s_bitcmp1_b32 s3, 0
    s_cselect_b64 s[42:43], s[18:19], s[16:17]
    global_load_dword v121, v120, s[42:43]
    s_mov_b64 exec, -1
Lng24:
    v_mov_b32 v40, 0
    v_mov_b32 v41, 0
    v_mov_b32 v42, 0
    v_mov_b32 v43, 0
    v_mov_b32 v44, 0
    v_mov_b32 v45, 0
    v_mov_b32 v46, 0
    v_mov_b32 v47, 0
    v_lshrrev_b32 v48, 4, v1
    v_lshl_add_u32 v48, v48, 2, v5
    v_lshl_add_u32 v81, v48, 5, s62
    v_bfe_u32 v48, v1, 2, 2
    v_lshl_add_u32 v48, v5, 2, v48
    v_lshlrev_b32 v82, 5, v48
    v_and_b32 v48, 15, v1
    v_bfe_u32 v49, v0, 4, 3
    v_mul_u32_u24 v49, 12544, v49
    v_lshl_add_u32 v83, v48, 3, v49
    s_lshl_b32 s42, s40, 7
    s_add_u32 s42, s42, 8192
    v_add_u32 v83, s42, v83
    s_waitcnt vmcnt(7)
    v_perm_b32 v48, v12, v8, s36
    v_perm_b32 v49, v12, v8, s37
    v_perm_b32 v50, v13, v9, s36
    v_perm_b32 v51, v13, v9, s37
    v_perm_b32 v52, v14, v10, s36
    v_perm_b32 v53, v14, v10, s37
    v_perm_b32 v54, v15, v11, s36
    v_perm_b32 v55, v15, v11, s37
    v_dot2c_f32_bf16_dpp v40, v80, v48 quad_perm:[0,0,0,0] row_mask:0xf bank_mask:0xf
    v_dot2c_f32_bf16_dpp v41, v80, v49 quad_perm:[0,0,0,0] row_mask:0xf bank_mask:0xf
    v_dot2c_f32_bf16_dpp v42, v80, v50 quad_perm:[0,0,0,0] row_mask:0xf bank_mask:0xf
    v_dot2c_f32_bf16_dpp v43, v80, v51 quad_perm:[0,0,0,0] row_mask:0xf bank_mask:0xf
    v_dot2c_f32_bf16_dpp v44, v80, v52 quad_perm:[0,0,0,0] row_mask:0xf bank_mask:0xf
    v_dot2c_f32_bf16_dpp v45, v80, v53 quad_perm:[0,0,0,0] row_mask:0xf bank_mask:0xf
    v_dot2c_f32_bf16_dpp v46, v80, v54 quad_perm:[0,0,0,0] row_mask:0xf bank_mask:0xf
    v_dot2c_f32_bf16_dpp v47, v80, v55 quad_perm:[0,0,0,0] row_mask:0xf bank_mask:0xf
    s_waitcnt vmcnt(5)
    v_perm_b32 v56, v20, v16, s36
    v_perm_b32 v57, v20, v16, s37
    v_perm_b32 v58, v21, v17, s36
    v_perm_b32 v59, v21, v17, s37
    v_perm_b32 v60, v22, v18, s36
    v_perm_b32 v61, v22, v18, s37
    v_perm_b32 v62, v23, v19, s36
    v_perm_b32 v63, v23, v19, s37
    v_dot2c_f32_bf16_dpp v40, v80, v56 quad_perm:[1,1,1,1] row_mask:0xf bank_mask:0xf
    v_dot2c_f32_bf16_dpp v41, v80, v57 quad_perm:[1,1,1,1] row_mask:0xf bank_mask:0xf
    v_dot2c_f32_bf16_dpp v42, v80, v58 quad_perm:[1,1,1,1] row_mask:0xf bank_mask:0xf
    v_dot2c_f32_bf16_dpp v43, v80, v59 quad_perm:[1,1,1,1] row_mask:0xf bank_mask:0xf
    v_dot2c_f32_bf16_dpp v44, v80, v60 quad_perm:[1,1,1,1] row_mask:0xf bank_mask:0xf
    v_dot2c_f32_bf16_dpp v45, v80, v61 quad_perm:[1,1,1,1] row_mask:0xf bank_mask:0xf
    v_dot2c_f32_bf16_dpp v46, v80, v62 quad_perm:[1,1,1,1] row_mask:0xf bank_mask:0xf
    v_dot2c_f32_bf16_dpp v47, v80, v63 quad_perm:[1,1,1,1] row_mask:0xf bank_mask:0xf
    s_waitcnt vmcnt(3)
    v_perm_b32 v64, v28, v24, s36
    v_perm_b32 v65, v28, v24, s37
    v_perm_b32 v66, v29, v25, s36
    v_perm_b32 v67, v29, v25, s37
    v_perm_b32 v68, v30, v26, s36
    v_perm_b32 v69, v30, v26, s37
    v_perm_b32 v70, v31, v27, s36
    v_perm_b32 v71, v31, v27, s37
    v_dot2c_f32_bf16_dpp v40, v80, v64 quad_perm:[2,2,2,2] row_mask:0xf bank_mask:0xf
    v_dot2c_f32_bf16_dpp v41, v80, v65 quad_perm:[2,2,2,2] row_mask:0xf bank_mask:0xf
    v_dot2c_f32_bf16_dpp v42, v80, v66 quad_perm:[2,2,2,2] row_mask:0xf bank_mask:0xf
    v_dot2c_f32_bf16_dpp v43, v80, v67 quad_perm:[2,2,2,2] row_mask:0xf bank_mask:0xf
    v_dot2c_f32_bf16_dpp v44, v80, v68 quad_perm:[2,2,2,2] row_mask:0xf bank_mask:0xf
    v_dot2c_f32_bf16_dpp v45, v80, v69 quad_perm:[2,2,2,2] row_mask:0xf bank_mask:0xf
    v_dot2c_f32_bf16_dpp v46, v80, v70 quad_perm:[2,2,2,2] row_mask:0xf bank_mask:0xf
    v_dot2c_f32_bf16_dpp v47, v80, v71 quad_perm:[2,2,2,2] row_mask:0xf bank_mask:0xf
    s_waitcnt vmcnt(1)
    v_perm_b32 v72, v36, v32, s36
    v_perm_b32 v73, v36, v32, s37
    v_perm_b32 v74, v37, v33, s36
    v_perm_b32 v75, v37, v33, s37
    v_perm_b32 v76, v38, v34, s36
    v_perm_b32 v77, v38, v34, s37
    v_perm_b32 v78, v39, v35, s36
    v_perm_b32 v79, v39, v35, s37
    v_dot2c_f32_bf16_dpp v40, v80, v72 quad_perm:[3,3,3,3] row_mask:0xf bank_mask:0xf
    v_dot2c_f32_bf16_dpp v41, v80, v73 quad_perm:[3,3,3,3] row_mask:0xf bank_mask:0xf
    v_dot2c_f32_bf16_dpp v42, v80, v74 quad_perm:[3,3,3,3] row_mask:0xf bank_mask:0xf
    v_dot2c_f32_bf16_dpp v43, v80, v75 quad_perm:[3,3,3,3] row_mask:0xf bank_mask:0xf
    v_dot2c_f32_bf16_dpp v44, v80, v76 quad_perm:[3,3,3,3] row_mask:0xf bank_mask:0xf
    v_dot2c_f32_bf16_dpp v45, v80, v77 quad_perm:[3,3,3,3] row_mask:0xf bank_mask:0xf
    v_dot2c_f32_bf16_dpp v46, v80, v78 quad_perm:[3,3,3,3] row_mask:0xf bank_mask:0xf
    v_dot2c_f32_bf16_dpp v47, v80, v79 quad_perm:[3,3,3,3] row_mask:0xf bank_mask:0xf
    s_nop 1
    v_permlane32_swap_b32 v40, v44
    v_permlane32_swap_b32 v41, v45
    v_permlane32_swap_b32 v42, v46
    v_permlane32_swap_b32 v43, v47
    v_add_f32 v40, v40, v44
    v_add_f32 v42, v42, v46
    v_add_f32 v41, v41, v45
    v_add_f32 v43, v43, v47
    v_permlane16_swap_b32 v40, v42
    s_nop 0
    v_permlane16_swap_b32 v41, v43
    v_add_f32 v40, v40, v42
    v_add_f32 v41, v41, v43
    s_nop 0
    v_add_f32_dpp v40, v40, v40 row_ror:8 row_mask:0xf bank_mask:0xf
    v_add_f32_dpp v41, v41, v41 row_ror:8 row_mask:0xf bank_mask:0xf
    s_nop 0
    v_add_f32_dpp v40, v40, v40 row_ror:4 row_mask:0xf bank_mask:0xf
    v_add_f32_dpp v41, v41, v41 row_ror:4 row_mask:0xf bank_mask:0xf
PM2:
    s_cbranch_execz Lexit1
    ds_write_b64 v81, v[40:41] offset:256
    s_and_b32 s44, s33, 3
    s_lshl_b32 s44, s44, 4
    s_lshr_b32 s42, s33, 2
    s_xor_b32 s42, s42, s3
    s_or_b32 s39, s39, s42
    s_bfm_b64 s[46:47], 16, s44
    s_cmp_eq_u32 s39, 0
    s_cselect_b64 s[46:47], s[46:47], 0
    s_andn2_b64 s[44:45], -1, s[46:47]
    s_waitcnt lgkmcnt(0)
    s_barrier
    s_cmp_ge_u32 s3, 2
    s_cbranch_scc1 Lnm25
    ds_read_b128 v[48:51], v82 offset:256
    ds_read_b128 v[52:55], v82 offset:272
    s_waitcnt lgkmcnt(0)
    v_pk_add_f32 v[48:49], v[48:49], v[50:51]
    v_pk_add_f32 v[52:53], v[52:53], v[54:55]
    v_pk_add_f32 v[48:49], v[48:49], v[52:53]
    v_cvt_pk_bf16_f32 v84, v48, v49
    s_mov_b64 exec, s[44:45]
    global_store_dwordx2 v83, v[84:85], s[30:31] sc1
    s_mov_b64 exec, s[46:47]
    s_cbranch_execz Low26
    global_store_dwordx2 v83, v[84:85], s[30:31]
Low26:
    s_mov_b64 exec, -1
Lnm25:
    s_barrier
    s_lshl_b32 s42, s34, 5
    v_xor_b32 v123, s42, v0
    s_mul_i32 s42, s34, 224
    v_min_u32 v120, 223, v0
    v_add_lshl_u32 v120, v120, s42, 3
    s_xor_b32 s42, s33, 4
    v_add_lshl_u32 v120, v120, s42, 7
    global_load_dword v121, v120, s[20:21]
    v_and_b32 v4, 16, v1
    v_and_b32 v5, 32, v1
    v_lshlrev_b32 v4, 6, v4
    v_lshl_add_u32 v4, v5, 1, v4
    v_and_b32 v5, 12, v1
    v_lshl_add_u32 v4, v5, 2, v4
    v_lshl_add_u32 v4, s3, 8, v4
    v_and_b32 v6, 3, v1
    v_lshlrev_b32 v4, 10, v4
    v_lshl_add_u32 v4, v6, 2, v4
    s_xor_b32 s42, s40, 32
    s_lshl4_add_u32 s42, s42, 4096
    v_add_u32 v4, s42, v4
    v_lshlrev_b32 v6, 7, v6
    v_lshl_add_u32 v6, v5, 1, v6
    v_lshl_add_u32 v6, s3, 5, v6
    v_and_b32 v7, 1, v0
    v_mul_u32_u24 v7, 0xaaaa, v7
    v_add_u32 v7, 0x4444, v7
    s_mov_b32 s46, 0x00f0000f
    s_mov_b32 s47, 0xf0000f00
    v_mov_b64 v[16:17], 0
    v_mov_b64 v[18:19], 0
    v_mov_b64 v[20:21], 0
    v_mov_b64 v[22:23], 0
    v_mov_b64 v[24:25], 0
    v_mov_b64 v[26:27], 0
    v_mov_b64 v[28:29], 0
    v_mov_b64 v[30:31], 0
    v_mov_b64 v[32:33], 0
    v_mov_b64 v[34:35], 0
    v_mov_b64 v[36:37], 0
    v_mov_b64 v[38:39], 0
    v_mov_b64 v[40:41], 0
    v_mov_b64 v[42:43], 0
    v_mov_b64 v[44:45], 0
    v_mov_b64 v[46:47], 0
    v_mov_b64 v[80:81], 0
    v_mov_b64 v[82:83], 0
    v_mov_b64 v[84:85], 0
    v_mov_b64 v[86:87], 0
    v_mov_b64 v[88:89], 0
    v_mov_b64 v[90:91], 0
    v_mov_b64 v[92:93], 0
    v_mov_b64 v[94:95], 0
    s_mul_i32 s42, s33, 7424
    s_add_u32 s42, s42, 806912
    v_lshl_add_u32 v2, v0, 4, s42
    s_cmp_eq_u32 s3, 3
    s_cselect_b32 s42, 0, 4096
    v_add_u32 v3, s42, v2
    s_cselect_b32 exec_lo, 0xffff, -1
    s_mov_b32 exec_hi, exec_lo
    s_barrier
    global_load_dword v16, v4, s[20:21] offset:-4096
    global_load_dword v17, v4, s[20:21] offset:-3072
    global_load_dword v18, v4, s[20:21] offset:-2048
    global_load_dword v19, v4, s[20:21] offset:-1024
    global_load_dword v20, v4, s[20:21] offset:0
    global_load_dword v21, v4, s[20:21] offset:1024
    global_load_dword v22, v4, s[20:21] offset:2048
    global_load_dword v23, v4, s[20:21] offset:3072
    v_add_u32 v4, 8192, v4
    global_load_dword v24, v4, s[20:21] offset:-4096
    global_load_dword v25, v4, s[20:21] offset:-3072
    global_load_dword v26, v4, s[20:21] offset:-2048
    global_load_dword v27, v4, s[20:21] offset:-1024
    global_load_dword v28, v4, s[20:21] offset:0
    global_load_dword v29, v4, s[20:21] offset:1024
    global_load_dword v30, v4, s[20:21] offset:2048
    global_load_dword v31, v4, s[20:21] offset:3072
    v_add_u32 v4, 122880, v4
    global_load_dword v32, v4, s[20:21] offset:-4096
    global_load_dword v33, v4, s[20:21] offset:-3072
    global_load_dword v34, v4, s[20:21] offset:-2048
    global_load_dword v35, v4, s[20:21] offset:-1024
    global_load_dword v36, v4, s[20:21] offset:0
    global_load_dword v37, v4, s[20:21] offset:1024
    global_load_dword v38, v4, s[20:21] offset:2048
    global_load_dword v39, v4, s[20:21] offset:3072
    v_add_u32 v4, 8192, v4
    global_load_dword v40, v4, s[20:21] offset:-4096
    global_load_dword v41, v4, s[20:21] offset:-3072
    global_load_dword v42, v4, s[20:21] offset:-2048
    global_load_dword v43, v4, s[20:21] offset:-1024
    global_load_dword v44, v4, s[20:21] offset:0
    global_load_dword v45, v4, s[20:21] offset:1024
    global_load_dword v46, v4, s[20:21] offset:2048
    global_load_dword v47, v4, s[20:21] offset:3072
    s_mov_b64 exec, -1
    s_branch Lpm3
PM3:
    s_endpgm
Lpm3:
    s_barrier
    global_load_dwordx4 v[96:99], v2, s[30:31] sc1
    global_load_dwordx4 v[100:103], v3, s[30:31] sc1
    s_waitcnt vmcnt(26)
    v_perm_b32 v48, v17, v16, s36
    v_perm_b32 v64, v17, v16, s37
    v_perm_b32 v50, v19, v18, s36
    v_perm_b32 v66, v19, v18, s37
    v_perm_b32 v49, v21, v20, s36
    v_perm_b32 v65, v21, v20, s37
    v_perm_b32 v51, v23, v22, s36
    v_perm_b32 v67, v23, v22, s37
    s_waitcnt vmcnt(18)
    v_perm_b32 v56, v25, v24, s36
    v_perm_b32 v72, v25, v24, s37
    v_perm_b32 v58, v27, v26, s36
    v_perm_b32 v74, v27, v26, s37
    v_perm_b32 v57, v29, v28, s36
    v_perm_b32 v73, v29, v28, s37
    v_perm_b32 v59, v31, v30, s36
    v_perm_b32 v75, v31, v30, s37
    s_waitcnt vmcnt(10)
    v_perm_b32 v52, v33, v32, s36
    v_perm_b32 v68, v33, v32, s37
    v_perm_b32 v54, v35, v34, s36
    v_perm_b32 v70, v35, v34, s37
    v_perm_b32 v53, v37, v36, s36
    v_perm_b32 v69, v37, v36, s37
    v_perm_b32 v55, v39, v38, s36
    v_perm_b32 v71, v39, v38, s37
    s_waitcnt vmcnt(2)
    v_perm_b32 v60, v41, v40, s36
    v_perm_b32 v76, v41, v40, s37
    v_perm_b32 v62, v43, v42, s36
    v_perm_b32 v78, v43, v42, s37
    v_perm_b32 v61, v45, v44, s36
    v_perm_b32 v77, v45, v44, s37
    v_perm_b32 v63, v47, v46, s36
    v_perm_b32 v79, v47, v46, s37
    s_branch Lpoll28
Lretry27:
    s_mov_b64 exec, vcc
    global_load_dwordx4 v[96:99], v2, s[30:31] sc1
    global_load_dwordx4 v[100:103], v3, s[30:31] sc1
    s_sub_u32 s35, s35, 1
    s_cbranch_scc1 Lexit
Lpoll28:
    s_waitcnt vmcnt(0)
    v_bitop3_b32 v104, v99, s32, v103 bitop3:0x7e
    v_cmp_ne_u32 vcc, 0, v104
    v_mov_b64 v[98:99], v[100:101]
    s_mov_b64 exec, -1
    s_cbranch_vccnz Lretry27
    v_smfmac_f32_16x16x64_bf16 v[80:83], v[96:99], v[48:55], v7
    v_smfmac_f32_16x16x64_bf16 v[84:87], v[96:99], v[56:63], v7
    v_smfmac_f32_16x16x64_bf16 v[88:91], v[96:99], v[64:71], v7
    v_smfmac_f32_16x16x64_bf16 v[92:95], v[96:99], v[72:79], v7
    s_mov_b64 exec, s[46:47]
    s_nop 4
    v_pk_add_f32 v[80:81], v[80:81], v[86:87]
    v_add_f32 v80, v80, v81
    v_pk_add_f32 v[88:89], v[88:89], v[94:95]
    v_add_f32 v81, v88, v89
    ds_write_b64 v6, v[80:81] offset:768
    s_waitcnt lgkmcnt(0)
    s_barrier
    s_endpgm
.p2align 12
LQ:
    s_mov_b32 s35, 0x100000
    s_mov_b32 s36, 0x05040100
    s_mov_b32 s37, 0x07060302
    s_and_b32 s34, s34, 7
    s_lshl3_add_u32 s40, s33, s34
    s_lshl_b32 s62, s3, 3
    v_and_b32 v5, 32, v0
    v_bfe_u32 v6, v0, 4, 1
    v_lshl_add_u32 v5, v6, 1, v5
    v_lshl_add_u32 v5, s3, 7, v5
    v_and_b32 v6, 15, v0
    v_lshlrev_b32 v4, 13, v5
    v_lshl_add_u32 v4, v6, 2, v4
    s_lshl_b32 s42, s40, 7
    v_add_u32 v4, s42, v4
    v_and_b32 v7, 7, v0
    v_bfe_u32 v93, v0, 3, 1
    v_lshl_add_u32 v92, v7, 1, v93
    v_and_or_b32 v3, v0, -16, v92
    v_lshlrev_b32 v7, 2, v3
    v_lshlrev_b32 v2, 4, v1
    s_mov_b32 s50, 32768
    s_mov_b32 s51, 294912
    s_waitcnt lgkmcnt(0)
    global_load_dword v118, v7, s[4:5]
    global_load_dwordx4 v[110:113], v2, s[4:5]
    s_add_u32 s14, s10, 8192
    s_addc_u32 s15, s11, 0
    s_add_u32 s26, s10, 64
    s_addc_u32 s27, s11, 0
    s_add_u32 s6, s10, 8256
    s_addc_u32 s7, s11, 0
    s_call_b64 s[60:61], Lload64
    s_load_dword s32, s[30:31], 0
    s_getreg_b32 s38, hwreg(HW_REG_XCC_ID, 0, 4)
    s_or_b32 s38, s38, 0x80
    s_mul_i32 s38, s38, 0x01010101
    v_and_b32 v126, 7, v0
    v_lshlrev_b32 v126, 2, v126
    v_lshl_add_u32 v126, s33, 5, v126
    s_lshl_b32 s42, s34, 7
    s_mul_i32 s43, s33, 9344
    s_add_u32 s43, s43, 868352
    s_add_u32 s43, s43, s42
    v_lshl_add_u32 v124, v1, 2, s43
    s_lshr_b32 s42, s34, 1
    s_lshl_b32 s42, s42, 11
    s_and_b32 s43, s34, 1
    s_lshl2_add_u32 s42, s43, s42
    s_mul_i32 s43, s33, 9344
    s_add_u32 s43, s43, 869376
    s_add_u32 s43, s43, s42
    v_lshl_add_u32 v125, v1, 6, s43
    s_mul_i32 s42, s33, 8448
    s_add_u32 s42, s42, 952320
    v_lshrrev_b32 v2, 3, v3
    v_mul_u32_u24 v2, 64, v2
    v_lshl_add_u32 v2, v3, 3, v2
    v_add_u32 v2, s42, v2
    s_lshl_b32 s42, s3, 8
    s_addk_i32 s42, 256
    v_lshl_add_u32 v75, v6, 4, s42
    v_bfe_u32 v109, v1, 4, 1
    v_lshl_add_u32 v109, v6, 2, v109
    v_lshlrev_b32 v109, 2, v109
    v_add_u32 v109, 256, v109
    v_and_b32 v74, 1, v0
    v_mul_u32_u24 v74, 0xaaaa, v74
    v_add_u32 v74, 0x4444, v74
    v_mov_b32 v7, 0
    v_mov_b32 v92, 0
    v_mov_b32 v93, 0
    s_mov_b32 s42, 0x3f803f80
    s_waitcnt vmcnt(32)
    v_dot2c_f32_bf16 v92, s42, v110
    v_dot2c_f32_bf16 v93, v110, v110
    v_dot2c_f32_bf16 v92, s42, v111
    v_dot2c_f32_bf16 v93, v111, v111
    v_dot2c_f32_bf16 v92, s42, v112
    v_dot2c_f32_bf16 v93, v112, v112
    v_dot2c_f32_bf16 v92, s42, v113
    v_dot2c_f32_bf16 v93, v113, v113
    v_and_b32 v119, 0xffff0000, v118
    v_lshlrev_b32 v118, 16, v118
    s_nop 0
    v_permlane32_swap_b32 v92, v93
    v_add_f32 v92, v92, v93
    s_nop 1
    v_add_f32_dpp v92, v92, v92 row_ror:8 row_mask:0xf bank_mask:0xf
    s_nop 1
    v_add_f32_dpp v92, v92, v92 row_ror:4 row_mask:0xf bank_mask:0xf
    s_nop 1
    v_add_f32_dpp v92, v92, v92 row_ror:2 row_mask:0xf bank_mask:0xf
    s_nop 1
    v_add_f32_dpp v92, v92, v92 row_ror:1 row_mask:0xf bank_mask:0xf
    s_nop 1
    v_add_f32_dpp v92, v92, v92 row_bcast:15 row_mask:0xa bank_mask:0xf
    s_nop 0
    v_readlane_b32 s42, v92, 31
    v_readlane_b32 s43, v92, 63
    s_nop 0
    v_mov_b32 v92, s42
    v_mov_b32 v93, s43
    v_mul_f32 v92, 0x3b000000, v92
    v_mul_f32 v93, 0x3b000000, v93
    v_fma_f32 v93, -v92, v92, v93
    v_max_f32 v93, 0, v93
    v_cvt_pk_bf16_f32 v92, v92, v93
    v_and_b32 v93, 0xffff0000, v92
    v_lshlrev_b32 v92, 16, v92
    v_add_f32 v93, 0x3727c5ac, v93
    v_cvt_pk_bf16_f32 v93, v93, v93
    v_lshlrev_b32 v93, 16, v93
    v_sqrt_f32 v93, v93
    s_nop 0
    v_cvt_pk_bf16_f32 v93, v93, v93
    v_lshlrev_b32 v93, 16, v93
    v_rcp_f32 v93, v93
    v_sub_f32 v118, v118, v92
    v_sub_f32 v119, v119, v92
    v_cvt_pk_bf16_f32 v118, v118, v119
    v_and_b32 v119, 0xffff0000, v118
    v_lshlrev_b32 v118, 16, v118
    v_mul_f32 v118, v118, v93
    v_mul_f32 v119, v119, v93
    v_cvt_pk_bf16_f32 v118, v118, v119
    v_and_b32 v119, 0xffff0000, v118
    v_lshlrev_b32 v118, 16, v118
    s_waitcnt lgkmcnt(0)
    s_mul_i32 s32, s32, 0x9e3779b1
    s_add_u32 s32, s32, 0x7f4a7c15
    v_mov_b32 v123, s32
    s_swappc_b64 s[60:61], s[60:61]
    global_load_dwordx2 v[114:115], v2, s[30:31] offset:-2048 sc1
    global_load_dwordx2 v[116:117], v2, s[30:31] offset:2048 sc1
    global_load_dword v127, v126, s[28:29] sc1
    s_waitcnt vmcnt(27)
    v_perm_b32 v12, v28, v13, s36
    v_perm_b32 v28, v28, v13, s37
    v_perm_b32 v44, v60, v45, s36
    v_perm_b32 v60, v60, v45, s37
    v_perm_b32 v13, v29, v20, s36
    v_perm_b32 v29, v29, v20, s37
    v_perm_b32 v45, v61, v52, s36
    v_perm_b32 v61, v61, v52, s37
    s_waitcnt vmcnt(19)
    v_perm_b32 v20, v36, v21, s36
    v_perm_b32 v36, v36, v21, s37
    v_perm_b32 v52, v68, v53, s36
    v_perm_b32 v68, v68, v53, s37
    v_perm_b32 v21, v37, v14, s36
    v_perm_b32 v37, v37, v14, s37
    v_perm_b32 v53, v69, v46, s36
    v_perm_b32 v69, v69, v46, s37
    s_waitcnt vmcnt(11)
    v_perm_b32 v14, v30, v15, s36
    v_perm_b32 v30, v30, v15, s37
    v_perm_b32 v46, v62, v47, s36
    v_perm_b32 v62, v62, v47, s37
    v_perm_b32 v15, v31, v22, s36
    v_perm_b32 v31, v31, v22, s37
    v_perm_b32 v47, v63, v54, s36
    v_perm_b32 v63, v63, v54, s37
    s_waitcnt vmcnt(7)
    v_perm_b32 v22, v38, v23, s36
    v_perm_b32 v38, v38, v23, s37
    v_perm_b32 v54, v70, v55, s36
    v_perm_b32 v70, v70, v55, s37
    s_waitcnt vmcnt(3)
    v_perm_b32 v23, v39, v72, s36
    v_perm_b32 v39, v39, v72, s37
    v_perm_b32 v55, v71, v73, s36
    v_perm_b32 v71, v71, v73, s37
    s_branch Lpoll30
.p2align 6
PQ3:
    s_endpgm
Lretry29:
    s_mov_b64 exec, vcc
    global_load_dwordx2 v[114:115], v2, s[30:31] offset:-2048 sc1
    global_load_dwordx2 v[116:117], v2, s[30:31] offset:2048 sc1
    global_load_dword v127, v126, s[28:29] sc1
    s_mov_b64 exec, -1
    s_sub_u32 s35, s35, 1
    s_cbranch_scc1 Lexit
Lpoll30:
    s_waitcnt vmcnt(0)
    v_bitop3_b32 v92, v115, s32, v117 bitop3:0x7e
    v_cmp_ne_u32 vcc, 0, v92
    s_cbranch_vccnz Lretry29
    v_and_b32 v117, 0xffff0000, v116
    v_lshlrev_b32 v116, 16, v116
    v_add_f32 v116, 1.0, v116
    v_add_f32 v117, 1.0, v117
    v_cmp_ne_u32 vcc, s38, v127
    s_mov_b32 s39, vcc_lo
    v_cvt_pk_bf16_f32 v116, v116, v117
    v_and_b32 v117, 0xffff0000, v116
    v_lshlrev_b32 v116, 16, v116
    v_pk_mul_f32 v[118:119], v[118:119], v[116:117]
    v_cvt_pk_bf16_f32 v118, v118, v119
    v_and_b32 v119, 0xffff0000, v118
    v_lshlrev_b32 v118, 16, v118
    v_and_b32 v115, 0xffff0000, v114
    v_lshlrev_b32 v114, 16, v114
    v_pk_add_f32 v[92:93], v[118:119], v[114:115]
    v_cvt_pk_bf16_f32 v96, v92, v93
    s_cmp_lg_u32 s3, 0
    s_nop 0
    v_mov_b32_dpp v97, v96 row_shl:4 row_mask:0xf bank_mask:0xf
    v_mov_b32_dpp v98, v96 row_shl:8 row_mask:0xf bank_mask:0xf
    v_mov_b32_dpp v99, v96 row_shl:12 row_mask:0xf bank_mask:0xf
    v_mov_b32_dpp v100, v96 row_shl:2 row_mask:0xf bank_mask:0xf
    v_mov_b32_dpp v101, v96 row_shl:6 row_mask:0xf bank_mask:0xf
    v_smfmac_f32_16x16x64_bf16 v[76:79], v[96:99], v[8:15], v74
    v_mov_b32_dpp v102, v96 row_shl:10 row_mask:0xf bank_mask:0xf
    v_smfmac_f32_16x16x64_bf16 v[80:83], v[96:99], v[40:47], v74
    v_mov_b32_dpp v103, v96 row_shl:14 row_mask:0xf bank_mask:0xf
    v_smfmac_f32_16x16x64_bf16 v[84:87], v[96:99], v[24:31], v74
    v_smfmac_f32_16x16x64_bf16 v[88:91], v[96:99], v[56:63], v74
    v_smfmac_f32_16x16x64_bf16 v[76:79], v[100:103], v[16:23], v74
    v_smfmac_f32_16x16x64_bf16 v[80:83], v[100:103], v[48:55], v74
    v_smfmac_f32_16x16x64_bf16 v[84:87], v[100:103], v[32:39], v74
    v_smfmac_f32_16x16x64_bf16 v[88:91], v[100:103], v[64:71], v74
    s_mov_b64 exec, 0xffff
    s_nop 3
    v_add_f32 v92, v76, v77
    v_add_f32 v93, v80, v81
    v_add_f32 v94, v84, v85
    v_add_f32 v95, v88, v89
    ds_write_b128 v75, v[92:95]
    s_mov_b64 exec, -1
    s_waitcnt lgkmcnt(0)
    s_barrier
    s_cbranch_scc1 LQ3
    ds_read2_b32 v[92:93], v109 offset0:0 offset1:2
    ds_read2_b32 v[94:95], v109 offset0:64 offset1:66
    ds_read2_b32 v[96:97], v109 offset0:128 offset1:130
    ds_read2_b32 v[98:99], v109 offset0:192 offset1:194
    s_mov_b32 exec_hi, 0
    s_waitcnt lgkmcnt(0)
    v_pk_add_f32 v[92:93], v[92:93], v[94:95]
    v_pk_add_f32 v[96:97], v[96:97], v[98:99]
    v_pk_add_f32 v[92:93], v[92:93], v[96:97]
    v_cvt_pk_bf16_f32 v122, v92, v93
    s_cmp_eq_u32 s39, 0
    s_cbranch_scc0 Lfar31
    global_store_dword v124, v122, s[30:31]
Lsd32:
    s_waitcnt vmcnt(0)
    s_cmp_eq_u32 s39, 0
    s_cbranch_scc0 Lfar33
    global_store_dword v125, v123, s[30:31]
Lsd34:
    s_mov_b64 exec, -1
LQ3:
    s_barrier
    s_lshl_b32 s42, s34, 5
    v_xor_b32 v123, s42, v0
    s_lshl_b32 s42, s34, 11
    s_mul_i32 s43, s33, 16640
    s_add_u32 s43, s43, 671744
    s_add_u32 s43, s43, s42
    v_lshrrev_b32 v120, 4, v0
    v_lshl_add_u32 v120, v120, 7, s43
    global_load_dword v121, v120, s[30:31] sc1
    s_lshr_b32 s42, s3, 1
    s_lshl1_add_u32 s42, s34, s42
    s_mul_i32 s42, s42, 2176
    s_mul_i32 s43, s33, 34816
    s_add_u32 s43, s43, 131072
    s_add_u32 s43, s43, s42
    s_and_b32 s42, s3, 1
    v_min_u32 v120, 8, v1
    v_lshl_add_u32 v120, s42, 3, v120
    v_lshl_add_u32 v120, v120, 7, s43
    global_load_dword v121, v120, s[30:31] sc1
    s_and_b32 s42, s34, 6
    s_add_u32 s42, s42, s34
    s_lshl4_add_u32 s42, s33, s42
    s_add_u32 s42, s42, 0
    s_lshl_b32 s42, s42, 15
    v_lshl_add_u32 v120, v123, 7, s42
    global_load_dword v121, v120, s[12:13]
    s_and_b32 s42, s34, 6
    s_add_u32 s42, s42, s34
    s_lshl4_add_u32 s42, s33, s42
    s_add_u32 s42, s42, 2
    s_lshl_b32 s42, s42, 15
    v_lshl_add_u32 v120, v123, 7, s42
    global_load_dword v121, v120, s[12:13]
    s_cmp_eq_u32 s33, 7
    s_cbranch_scc1 Lng35
    s_lshr_b32 s42, s3, 1
    s_lshl1_add_u32 s42, s34, s42
    s_and_b32 s43, s42, 12
    s_add_u32 s42, s42, s43
    s_lshl_b32 s42, s42, 4
    s_addk_i32 s42, 0
    v_lshrrev_b32 v120, 2, v1
    v_add_u32 v120, s42, v120
    v_bfe_u32 v122, v1, 0, 2
    v_mad_u32_u24 v120, v120, 28, v122
    s_min_u32 s42, s33, 6
    s_lshl_b32 s42, s42, 2
    v_add_lshl_u32 v120, v120, s42, 7
    s_bitcmp1_b32 s3, 0
    s_cselect_b64 s[42:43], s[18:19], s[16:17]
    global_load_dword v121, v120, s[42:43]
Lng35:
    s_cmp_eq_u32 s33, 7
    s_cbranch_scc1 Lexit
    v_lshlrev_b32 v2, 2, v3
    global_load_dword v110, v2, s[4:5]
    s_mul_i32 s42, s33, 12544
    s_add_u32 s42, s42, 10240
    v_lshl_add_u32 v2, v3, 3, s42
    s_mul_i32 s42, s33, 16640
    s_add_u32 s42, s42, 675840
    v_and_b32 v109, 15, v3
    v_bfe_u32 v93, v1, 4, 1
    v_lshl_add_u32 v109, v109, 1, v93
    v_lshrrev_b32 v92, 5, v1
    v_lshl_add_u32 v109, v109, 1, v92
    v_lshlrev_b32 v109, 2, v109
    v_add_u32 v109, 2048, v109
    v_lshlrev_b32 v75, 4, v0
    v_lshl_add_u32 v125, v93, 1, v92
    v_lshlrev_b32 v125, 2, v125
    v_lshl_add_u32 v125, s3, 10, v125
    v_lshrrev_b32 v92, 1, v3
    v_and_b32 v93, 1, v3
    v_lshl_add_u32 v92, v92, 4, s42
    v_lshl_add_u32 v3, v93, 13, v92
    v_mul_u32_u24 v4, 3584, v5
    v_lshl_add_u32 v4, v6, 2, v4
    s_lshl_b32 s42, s40, 6
    v_add_u32 v4, s42, v4
    s_movk_i32 s50, 14336
    s_mov_b32 s51, 129024
    s_mov_b64 s[10:11], s[16:17]
    s_add_u32 s14, s16, 3584
    s_addc_u32 s15, s17, 0
    s_mov_b64 s[26:27], s[18:19]
    s_add_u32 s6, s18, 3584
    s_addc_u32 s7, s19, 0
    v_lshrrev_b32 v92, 3, v1
    v_mul_u32_u24 v92, 7424, v92
    v_and_b32 v93, 7, v1
    v_lshl_add_u32 v124, v93, 4, v92
    s_mov_b32 s46, 0x3b000000
    s_mov_b32 s47, 0x3b000000
    v_mov_b32 v126, 0
    v_mov_b32 v127, 0x3727c5ac
    s_lshl_b32 s42, s40, 7
    s_add_u32 s42, s42, 806912
    v_add_u32 v124, s42, v124
    s_mov_b32 s54, 0x0c04000c
    s_mov_b32 s55, 0x0402010c
    s_mov_b32 s56, 0x07060501
    s_mov_b32 s57, 0x07060502
    s_mov_b32 s58, 0x07060503
    s_mul_i32 s20, s33, 8
    s_bfm_b64 s[22:23], 8, s20
    s_cmp_eq_u32 s39, 0
    s_cselect_b64 s[22:23], s[22:23], 0
    s_andn2_b64 s[20:21], -1, s[22:23]
    s_barrier
    s_branch LG2
PQ2:
    s_endpgm
LG2:
    s_call_b64 s[60:61], Lload64
    s_swappc_b64 s[60:61], s[60:61]
    global_load_dwordx2 v[112:113], v2, s[30:31] offset:-2048 sc1
    global_load_dwordx2 v[114:115], v2, s[30:31] sc1
    global_load_dwordx2 v[116:117], v2, s[30:31] offset:2048 sc1
    global_load_dwordx4 v[92:95], v3, s[30:31] offset:-4096 sc1
    global_load_dwordx4 v[96:99], v3, s[30:31] offset:-2048 sc1
    global_load_dwordx4 v[100:103], v3, s[30:31] offset:0 sc1
    global_load_dwordx4 v[104:107], v3, s[30:31] offset:2048 sc1
    s_waitcnt vmcnt(31)
    v_perm_b32 v12, v28, v13, s36
    v_perm_b32 v28, v28, v13, s37
    v_perm_b32 v44, v60, v45, s36
    v_perm_b32 v60, v60, v45, s37
    v_perm_b32 v13, v29, v20, s36
    v_perm_b32 v29, v29, v20, s37
    v_perm_b32 v45, v61, v52, s36
    v_perm_b32 v61, v61, v52, s37
    s_waitcnt vmcnt(23)
    v_perm_b32 v20, v36, v21, s36
    v_perm_b32 v36, v36, v21, s37
    v_perm_b32 v52, v68, v53, s36
    v_perm_b32 v68, v68, v53, s37
    v_perm_b32 v21, v37, v14, s36
    v_perm_b32 v37, v37, v14, s37
    v_perm_b32 v53, v69, v46, s36
    v_perm_b32 v69, v69, v46, s37
    s_waitcnt vmcnt(15)
    v_perm_b32 v14, v30, v15, s36
    v_perm_b32 v30, v30, v15, s37
    v_perm_b32 v46, v62, v47, s36
    v_perm_b32 v62, v62, v47, s37
    v_perm_b32 v15, v31, v22, s36
    v_perm_b32 v31, v31, v22, s37
    v_perm_b32 v47, v63, v54, s36
    v_perm_b32 v63, v63, v54, s37
    s_waitcnt vmcnt(11)
    v_perm_b32 v22, v38, v23, s36
    v_perm_b32 v38, v38, v23, s37
    v_perm_b32 v54, v70, v55, s36
    v_perm_b32 v70, v70, v55, s37
    s_waitcnt vmcnt(7)
    v_perm_b32 v23, v39, v72, s36
    v_perm_b32 v39, v39, v72, s37
    v_perm_b32 v55, v71, v73, s36
    v_perm_b32 v71, v71, v73, s37
    s_waitcnt vmcnt(4)
    s_branch Lpoll37
Lretry36:
    global_load_dwordx2 v[112:113], v2, s[30:31] offset:-2048 sc1
    global_load_dwordx2 v[114:115], v2, s[30:31] sc1
    global_load_dwordx2 v[116:117], v2, s[30:31] offset:2048 sc1
    s_sub_u32 s35, s35, 1
    s_cbranch_scc1 Lexit
    s_waitcnt vmcnt(0)
Lpoll37:
    v_bitop3_b32 v108, v113, s32, v115 bitop3:0x7e
    v_bitop3_b32 v108, v117, s32, v108 bitop3:0xbe
    v_cmp_ne_u32 vcc, 0, v108
    s_cbranch_vccnz Lretry36
    v_and_b32 v117, 0xffff0000, v116
    v_lshlrev_b32 v116, 16, v116
    v_add_f32 v116, 1.0, v116
    v_add_f32 v117, 1.0, v117
    v_cvt_pk_bf16_f32 v115, v116, v117
    v_mov_b32_dpp v4, v114 row_ror:8 row_mask:0xf bank_mask:0x4
    v_mov_b32_dpp v5, v114 row_ror:4 row_mask:0xf bank_mask:0x4
    v_mov_b32_dpp v6, v114 quad_perm:[0,1,2,3] row_mask:0xf bank_mask:0x4
    v_mov_b32_dpp v7, v114 row_ror:12 row_mask:0xf bank_mask:0x4
    v_mov_b32_dpp v120, v114 row_ror:6 row_mask:0xf bank_mask:0x4
    v_mov_b32_dpp v121, v114 row_ror:2 row_mask:0xf bank_mask:0x4
    v_mov_b32_dpp v122, v114 row_ror:14 row_mask:0xf bank_mask:0x4
    v_mov_b32_dpp v123, v114 row_ror:10 row_mask:0xf bank_mask:0x4
    v_mov_b32_dpp v4, v115 row_ror:4 row_mask:0xf bank_mask:0x2
    v_mov_b32_dpp v5, v115 quad_perm:[0,1,2,3] row_mask:0xf bank_mask:0x2
    v_mov_b32_dpp v6, v115 row_ror:12 row_mask:0xf bank_mask:0x2
    v_mov_b32_dpp v7, v115 row_ror:8 row_mask:0xf bank_mask:0x2
    v_mov_b32_dpp v120, v115 row_ror:2 row_mask:0xf bank_mask:0x2
    v_mov_b32_dpp v121, v115 row_ror:14 row_mask:0xf bank_mask:0x2
    v_mov_b32_dpp v122, v115 row_ror:10 row_mask:0xf bank_mask:0x2
    v_mov_b32_dpp v123, v115 row_ror:6 row_mask:0xf bank_mask:0x2
    v_and_b32 v111, 0xffff0000, v110
    v_lshlrev_b32 v110, 16, v110
    v_and_b32 v113, 0xffff0000, v112
    v_lshlrev_b32 v112, 16, v112
    v_and_b32 v117, 0xffff0000, v115
    v_lshlrev_b32 v116, 16, v115
    v_mov_b32 v72, 2824
    s_branch Lpoll39
PQ4:
    s_endpgm
Lretry38:
    s_mov_b64 exec, vcc
    global_load_dwordx4 v[92:95], v3, s[30:31] offset:-4096 sc1
    global_load_dwordx4 v[96:99], v3, s[30:31] offset:-2048 sc1
    global_load_dwordx4 v[100:103], v3, s[30:31] offset:0 sc1
    global_load_dwordx4 v[104:107], v3, s[30:31] offset:2048 sc1
    s_sub_u32 s35, s35, 1
    s_cbranch_scc1 Lexit
Lpoll39:
    s_waitcnt vmcnt(0)
    v_bitop3_b32 v108, v95, s32, v99 bitop3:0x7e
    v_bitop3_b32 v108, v103, s32, v108 bitop3:0xbe
    v_bitop3_b32 v108, v107, s32, v108 bitop3:0xbe
    v_cmp_ne_u32 vcc, 0, v108
    v_perm_b32 v95, v93, v92, s54
    v_perm_b32 v95, v94, v95, s55
    v_perm_b32 v99, v97, v96, s54
    v_perm_b32 v99, v98, v99, s55
    s_mov_b64 exec, -1
    s_cbranch_vccnz Lretry38
    v_perm_b32 v103, v101, v100, s54
    v_perm_b32 v103, v102, v103, s55
    v_perm_b32 v107, v105, v104, s54
    v_perm_b32 v107, v106, v107, s55
    v_pk_add_f32 v[94:95], v[94:95], v[98:99]
    v_pk_add_f32 v[102:103], v[102:103], v[106:107]
    v_pk_add_f32 v[92:93], v[92:93], v[96:97]
    v_pk_add_f32 v[94:95], v[94:95], v[102:103]
    v_pk_add_f32 v[100:101], v[100:101], v[104:105]
    v_pk_fma_f32 v[110:111], v[100:101], v[112:113], v[110:111]
    v_add_f32_dpp v118, v94, v92 row_ror:8 row_mask:0xf bank_mask:0xf
    v_add_f32_dpp v119, v95, v93 row_ror:8 row_mask:0xf bank_mask:0xf
    v_pk_fma_f32 v[118:119], v[118:119], v[112:113], v[110:111]
    v_pk_mul_f32 v[96:97], v[118:119], v[116:117]
    v_cvt_pk_bf16_f32 v96, v96, v97
    v_mul_f32 v93, v118, v118
    v_add_f32 v92, v118, v119
    v_mov_b32_dpp v4, v96 quad_perm:[0,1,2,3] row_mask:0xf bank_mask:0x1
    v_mov_b32_dpp v5, v96 row_ror:12 row_mask:0xf bank_mask:0x1
    v_mov_b32_dpp v6, v96 row_ror:8 row_mask:0xf bank_mask:0x1
    v_mov_b32_dpp v7, v96 row_ror:4 row_mask:0xf bank_mask:0x1
    v_fmac_f32 v93, v119, v119
    v_mov_b32_dpp v120, v96 row_ror:14 row_mask:0xf bank_mask:0x1
    v_smfmac_f32_16x16x64_bf16 v[76:79], v[4:7], v[8:15], v74
    v_permlane32_swap_b32 v92, v93
    v_smfmac_f32_16x16x64_bf16 v[80:83], v[4:7], v[40:47], v74
    v_add_f32 v92, v92, v93
    v_mov_b32_dpp v121, v96 row_ror:10 row_mask:0xf bank_mask:0x1
    v_smfmac_f32_16x16x64_bf16 v[84:87], v[4:7], v[24:31], v74
    v_mov_b32_dpp v122, v96 row_ror:6 row_mask:0xf bank_mask:0x1
    v_mov_b32_dpp v123, v96 row_ror:2 row_mask:0xf bank_mask:0x1
    v_smfmac_f32_16x16x64_bf16 v[88:91], v[4:7], v[56:63], v74
    v_add_f32_dpp v92, v92, v92 row_ror:8 row_mask:0xf bank_mask:0xf
    v_smfmac_f32_16x16x64_bf16 v[76:79], v[120:123], v[16:23], v74
    s_cmp_lg_u32 s3, 0
    v_add_f32_dpp v92, v92, v92 row_ror:4 row_mask:0xf bank_mask:0xf
    v_smfmac_f32_16x16x64_bf16 v[80:83], v[120:123], v[48:55], v74
    v_mov_b32 v103, s32
    v_add_f32_dpp v92, v92, v92 row_ror:2 row_mask:0xf bank_mask:0xf
    v_smfmac_f32_16x16x64_bf16 v[84:87], v[120:123], v[32:39], v74
    s_nop 0
    v_add_f32_dpp v92, v92, v92 row_ror:1 row_mask:0xf bank_mask:0xf
    v_smfmac_f32_16x16x64_bf16 v[88:91], v[120:123], v[64:71], v74
    v_add_f32 v96, v76, v77
    v_add_f32_dpp v92, v92, v92 row_bcast:15 row_mask:0xa bank_mask:0xf
    v_add_f32 v97, v80, v81
    ds_write_b32 v125, v92 offset:2816
    s_mov_b32 exec_hi, 0xffff
    v_add_f32 v98, v84, v85
    s_nop 1
    v_add_f32 v99, v88, v89
    ds_write_b128 v75, v[96:99] offset:2048
    s_mov_b32 exec_hi, -1
    s_cbranch_scc1 LGw
    s_waitcnt lgkmcnt(0)
    s_barrier
    ds_read2st64_b64 v[8:11], v72 offset0:0 offset1:2
    ds_read2st64_b64 v[12:15], v72 offset0:4 offset1:6
    ds_read2st64_b32 v[16:17], v109 offset0:0 offset1:1
    ds_read2st64_b32 v[18:19], v109 offset0:4 offset1:5
    ds_read2st64_b32 v[20:21], v109 offset0:8 offset1:9
    ds_read2st64_b32 v[22:23], v109 offset0:12 offset1:13
    ds_read2st64_b32 v[24:25], v109 offset0:2 offset1:6
    ds_read2st64_b32 v[26:27], v109 offset0:10 offset1:14
    s_waitcnt lgkmcnt(6)
    v_pk_add_f32 v[8:9], v[8:9], v[10:11]
    v_pk_add_f32 v[12:13], v[12:13], v[14:15]
    v_pk_add_f32 v[8:9], v[8:9], v[12:13]
    v_pk_fma_f32 v[8:9], v[8:9], s[46:47], v[126:127]
    v_fma_f32 v9, -v8, v8, v9
    v_max_f32 v9, v9, v127
    v_rsq_f32 v10, v9
    s_waitcnt lgkmcnt(0)
    v_pk_add_f32 v[16:17], v[16:17], v[18:19]
    v_pk_add_f32 v[20:21], v[20:21], v[22:23]
    v_pk_add_f32 v[16:17], v[16:17], v[20:21]
    v_pk_add_f32 v[24:25], v[24:25], v[26:27]
    v_fma_f32 v16, -v8, v17, v16
    v_add_f32 v24, v24, v25
    v_pk_fma_f32 v[92:93], v[16:17], v[10:11], v[24:25] op_sel_hi:[0,0,0]
    s_nop 1
    v_permlane32_swap_b32 v92, v93
    v_mul_f32 v94, 0xbfb8aa3b, v92
    v_exp_f32 v94, v94
    v_mul_f32 v92, v92, v93
    v_add_f32 v94, 1.0, v94
    v_rcp_f32 v93, v94
    s_nop 0
    v_pk_mul_f32 v[92:93], v[92:93], v[92:93] op_sel:[0,1] op_sel_hi:[0,1]
    s_nop 1
    v_permlane16_swap_b32 v92, v93
    v_cvt_pk_bf16_f32 v100, v92, v93
    v_cvt_pk_bf16_f32 v101, v92, v93
    s_nop 0
    v_mov_b32_dpp v100, v100 row_ror:8 row_mask:0xf bank_mask:0xc
    v_mov_b32_dpp v101, v101 row_ror:8 row_mask:0xf bank_mask:0x3
    s_mov_b64 exec, s[20:21]
    global_store_dwordx4 v124, v[100:103], s[30:31] sc1
    s_mov_b64 exec, s[22:23]
    s_cbranch_execz Low40
    global_store_dwordx4 v124, v[100:103], s[30:31]
Low40:
    s_mov_b64 exec, -1
    s_endpgm
LGw:
    s_waitcnt lgkmcnt(0)
    s_barrier
    s_endpgm
Lfar31:
    global_store_dword v124, v122, s[30:31] sc1
    s_branch Lsd32
Lfar33:
    global_store_dword v125, v123, s[30:31] sc1
    s_branch Lsd34
Lexit1:
Lexit:
Lexit0:
    s_endpgm
.section .rodata,"a"
.p2align 6
.amdhsa_kernel adaLN_cond__sliding_block_cached__swiglu_ffn__decode_kernel
  .amdhsa_next_free_vgpr 128
  .amdhsa_next_free_sgpr 102
  .amdhsa_accum_offset 128
  .amdhsa_group_segment_fixed_size 0
  .amdhsa_kernarg_size 112
  .amdhsa_user_sgpr_count 2
  .amdhsa_user_sgpr_kernarg_segment_ptr 1
  .amdhsa_system_sgpr_workgroup_id_x 1
  .amdhsa_float_denorm_mode_32 3
.end_amdhsa_kernel
```
